```python
import torch

def _softmax(x, axis=-1):
    return torch.softmax(x, dim=axis)
def _gelu(x):
    return torch.nn.functional.gelu(x, approximate="tanh")
def _silu(x):
    return torch.nn.functional.silu(x)
def _sigmoid(x):
    return torch.sigmoid(x)
def _layernorm(x, axis=-1, eps=1e-5):
    m = x.mean(dim=axis, keepdim=True)
    v = x.var(dim=axis, keepdim=True, unbiased=False)
    return (x - m) / torch.sqrt(v + eps)
def _scatter_add(tgt, idx, src, axis=0):
    return tgt.clone().index_add_(axis, idx, src)
def _segment_sum(src, seg, n):
    out = torch.zeros((n,) + src.shape[1:], dtype=src.dtype)
    return out.index_add_(0, seg, src)
def _pad(x, pw):
    flat = tuple(v for pair in reversed(pw) for v in pair)
    return torch.nn.functional.pad(x, flat)

kernel_name = 'recurrent_scan__ssm_conv_s5__glu_gated_reglu__prompt'

def setup_inputs():

    _w = (lambda a: (lambda t: t.to(torch.bfloat16) if t.is_floating_point() else t)(torch.as_tensor(a)))
    def _A_setup():
        B, S, D = 1, 2048, 448
        P = D
        Lambda_re = -0.5 * (lambda _x: torch.exp(torch.as_tensor(_x)))((lambda *s: torch.randn(*s, dtype=torch.bfloat16) * 0.8)(P))
        Lambda_im = (lambda *s: torch.randn(*s, dtype=torch.bfloat16) * 0.8)(P) * 1.0
        B_re = (lambda *s: torch.randn(*s, dtype=torch.bfloat16) * 0.8)(P, D) * (D ** -0.5)
        B_im = (lambda *s: torch.randn(*s, dtype=torch.bfloat16) * 0.8)(P, D) * (D ** -0.5)
        C_re = (lambda *s: torch.randn(*s, dtype=torch.bfloat16) * 0.8)(D, P) * (P ** -0.5)
        C_im = (lambda *s: torch.randn(*s, dtype=torch.bfloat16) * 0.8)(D, P) * (P ** -0.5)
        log_dt = (lambda *s: torch.randn(*s, dtype=torch.bfloat16) * 0.8)(P) * 0.3 - 2.0
        Dskip = (lambda *s: torch.randn(*s, dtype=torch.bfloat16) * 0.8)(D)
        return {
            "x": _w((lambda *s: torch.randn(*s, dtype=torch.bfloat16) * 0.05)(B, S, D)),
            "Lambda_re": _w(Lambda_re),
            "Lambda_im": _w(Lambda_im),
            "B_re": _w(B_re),
            "B_im": _w(B_im),
            "C_re": _w(C_re),
            "C_im": _w(C_im),
            "log_dt": _w(log_dt),
            "Dskip": _w(Dskip),
        }
    _A_in = _A_setup()

    def _B_setup():
        B, S, D, F = 1, 2048, 448, 1792
        return {
            "x": _w((lambda *s: torch.randn(*s, dtype=torch.bfloat16) * 0.05)(B, S, D)),
            "W_gate": _w((lambda *s: torch.randn(*s, dtype=torch.bfloat16) * 0.2)(D, F) * (2.0 / D) ** 0.5),
            "W_up": _w((lambda *s: torch.randn(*s, dtype=torch.bfloat16) * 0.2)(D, F) * (2.0 / D) ** 0.5),
            "W_down": _w((lambda *s: torch.randn(*s, dtype=torch.bfloat16) * 0.2)(F, D) * (1.0 / F) ** 0.5),
        }
    _B_in = _B_setup()

    return {
        "A_x": _A_in["x"],
        "A_Lambda_re": _A_in["Lambda_re"],
        "A_Lambda_im": _A_in["Lambda_im"],
        "A_B_re": _A_in["B_re"],
        "A_B_im": _A_in["B_im"],
        "A_C_re": _A_in["C_re"],
        "A_C_im": _A_in["C_im"],
        "A_log_dt": _A_in["log_dt"],
        "A_Dskip": _A_in["Dskip"],
        "B_x": _B_in["x"],
        "B_W_gate": _B_in["W_gate"],
        "B_W_up": _B_in["W_up"],
        "B_W_down": _B_in["W_down"],
    }

def reference(A_x, A_Lambda_re, A_Lambda_im, A_B_re, A_B_im, A_C_re, A_C_im, A_log_dt, A_Dskip, B_x, B_W_gate, B_W_up, B_W_down):
    def _A_ref(x, Lambda_re, Lambda_im, B_re, B_im, C_re, C_im, log_dt, Dskip):
        Bsz, L, H = x.shape
        Lam = Lambda_re + 1j * Lambda_im
        Bmat = B_re + 1j * B_im
        Cmat = C_re + 1j * C_im
        dt = torch.exp(log_dt)
        Lam_bar = torch.exp(dt * Lam)
        B_bar = ((Lam_bar - 1.0) / Lam)[:, None] * Bmat
        Bu = torch.einsum("bld,pd->blp", x + 0j, B_bar)
        h = torch.zeros_like(Bu[:, 0, :])
        hs = []
        for t in range(L):
            h = Lam_bar[None, :] * h + Bu[:, t, :]
            hs.append(h)
        hseq = torch.stack(hs, 1)
        y = 2.0 * torch.einsum("blp,dp->bld", hseq, Cmat).real + x * Dskip[None, None, :]
        return y

    def _B_ref(x, W_gate, W_up, W_down):
        gate = torch.einsum("bsd,df->bsf", x, W_gate)
        up = torch.einsum("bsd,df->bsf", x, W_up)
        gate = gate * (lambda x, dt: x.to(dt))(gate > 0, gate.dtype)
        h = gate * up
        return torch.einsum("bsf,fd->bsd", h, W_down)

    x = A_x
    xn = _layernorm(x, axis=-1)
    s = _A_ref(xn, A_Lambda_re, A_Lambda_im, A_B_re, A_B_im, A_C_re, A_C_im, A_log_dt, A_Dskip)
    g = _silu(_B_ref(xn, B_W_gate, B_W_up, B_W_down))
    return x + s * g
```

```asm
; @launch grid=(256,1,1) block=(512,1,1) lds=163840
.amdgcn_target "amdgcn-amd-amdhsa--gfx950"
.text
.globl recurrent_scan__ssm_conv_s5__glu_gated_reglu__prompt_kernel
.p2align 12
.p2align 8
.type recurrent_scan__ssm_conv_s5__glu_gated_reglu__prompt_kernel,@function
recurrent_scan__ssm_conv_s5__glu_gated_reglu__prompt_kernel:
    s_cmp_ge_u32 s2, 256
    s_cbranch_scc1 L_exit
    s_load_dwordx16 s[16:31], s[0:1], 0
    s_load_dwordx16 s[32:47], s[0:1], 64
    v_lshrrev_b32 v1, 6, v0
    v_and_b32 v0, 63, v0
    v_readfirstlane_b32 s3, v1
    s_and_b32 s4, s2, 7
    s_lshr_b32 s5, s2, 3
    s_cmp_gt_u32 s3, 0
    s_cbranch_scc1 L_nocpf
    s_getpc_b64 s[12:13]
L_pc0:
    s_sub_u32 s12, s12, L_pc0-recurrent_scan__ssm_conv_s5__glu_gated_reglu__prompt_kernel
    s_subb_u32 s13, s13, 0
    s_lshl_b32 s11, s3, 5
    s_add_u32 s11, s11, s5
    s_lshl_b32 s11, s11, 10
    v_lshl_add_u32 v38, v0, 4, s11
    v_min_u32 v38, L_exit-recurrent_scan__ssm_conv_s5__glu_gated_reglu__prompt_kernel, v38
    global_load_dword v23, v38, s[12:13]
L_nocpf:
    s_and_b32 s11, s5, 3
    s_lshr_b32 s9, s5, 2
    s_and_b32 s12, s4, 1
    s_lshl_b32 s12, s12, 2
    s_add_u32 s6, s12, s11
    s_lshr_b32 s12, s4, 1
    s_mul_i32 s12, s12, 7
    s_add_u32 s7, s12, s9
    s_and_b32 s12, s4, 1
    s_lshl_b32 s12, s12, 2
    s_lshr_b32 s13, s4, 1
    s_add_u32 s12, s12, s13
    s_lshl_b32 s12, s12, 2
    s_add_u32 s8, s12, s11
    s_and_b32 s10, s3, 3
    s_cmp_ge_u32 s5, 28
    s_cbranch_scc1 L_helper
    s_cmp_lt_u32 s3, 4
    s_cbranch_scc1 L_consumer
L_loader:
    s_setprio 3
    v_lshrrev_b32 v24, 3, v0
    v_and_b32 v25, 7, v0
    v_lshrrev_b32 v17, 1, v24
    s_lshl_b32 s11, s10, 4
    v_add_u32 v15, s11, v24
    v_mul_u32_u24 v3, 3584, v15
    v_and_b32 v19, 1, v17
    v_lshlrev_b32 v19, 2, v19
    v_xor_b32 v19, v25, v19
    v_lshl_add_u32 v3, v19, 4, v3
    s_lshl_b32 s11, s7, 7
    v_add_u32 v3, s11, v3
    v_xor_b32 v12, 32, v3
    s_lshl_b32 s11, s6, 8
    s_lshl_b32 s12, s10, 6
    s_add_u32 s11, s11, s12
    v_lshrrev_b32 v15, 2, v24
    v_and_b32 v16, 3, v24
    v_lshl_add_u32 v15, v15, 4, v16
    v_add_u32 v15, s11, v15
    v_mul_u32_u24 v1, 896, v15
    v_xor_b32 v18, v25, v17
    v_lshl_add_u32 v1, v18, 4, v1
    v_xor_b32 v2, 64, v1
    s_and_b32 s12, s10, 1
    s_lshl_b32 s11, s7, 4
    s_lshl_b32 s13, s12, 3
    s_add_u32 s11, s11, s13
    v_add_u32 v15, s11, v24
    v_mul_u32_u24 v4, 896, v15
    v_lshl_add_u32 v4, v18, 4, v4
    s_lshl_b32 s13, s12, 6
    v_xor_b32 v4, s13, v4
    s_lshl_b32 s72, s10, 13
    s_lshl_b32 s74, s10, 11
    s_lshl_b32 s75, s10, 10
    s_mul_i32 s70, s10, 12288
    s_mov_b32 s68, 0x6543210
    s_and_b32 s11, s5, 3
    s_add_u32 s11, s11, s9
    s_mul_i32 s13, s11, 43
    s_lshr_b32 s13, s13, 7
    s_mul_i32 s13, s13, 3
    s_sub_u32 s11, s11, s13
    s_cmp_eq_u32 s11, 1
    s_cmov_b32 s68, 0x6354021
    s_cmp_eq_u32 s11, 2
    s_cmov_b32 s68, 0x6435102
    s_waitcnt lgkmcnt(0)
    s_mov_b32 s52, s36
    s_and_b32 s53, s37, 0xffff
    s_mov_b32 s54, 0x188000
    s_mov_b32 s55, 0x20000
    s_mov_b32 s48, s16
    s_and_b32 s49, s17, 0xffff
    s_mov_b32 s50, 0x1c0000
    s_mov_b32 s51, 0x20000
    s_mov_b32 s56, s38
    s_and_b32 s57, s39, 0xffff
    s_mov_b32 s58, 0x188000
    s_mov_b32 s59, 0x20000
    s_cmp_ge_u32 s10, 2
    s_cselect_b32 s60, s24, s22
    s_cselect_b32 s61, s25, s23
    s_and_b32 s61, s61, 0xffff
    s_mov_b32 s62, 0x62000
    s_mov_b32 s63, 0x20000
    s_bfe_u32 s69, s68, 0x40000
    s_mul_i32 s15, s69, 229376
    s_lshl_b32 s69, s69, 7
    s_add_u32 m0, s74, 32768
    s_add_u32 s11, s15, 0
    buffer_load_dwordx4 v3, s[52:55], s11 offen lds
    s_add_u32 m0, s74, 33792
    s_add_u32 s11, s15, 28672
    buffer_load_dwordx4 v12, s[52:55], s11 offen lds
    s_add_u32 m0, s72, 0
    s_add_u32 s11, s69, 0
    buffer_load_dwordx4 v1, s[48:51], s11 offen lds
    s_add_u32 m0, s72, 1024
    s_add_u32 s11, s69, 3584
    buffer_load_dwordx4 v2, s[48:51], s11 offen lds
    s_add_u32 m0, s72, 2048
    s_add_u32 s11, s69, 7168
    buffer_load_dwordx4 v1, s[48:51], s11 offen lds
    s_add_u32 m0, s72, 3072
    s_add_u32 s11, s69, 10752
    buffer_load_dwordx4 v2, s[48:51], s11 offen lds
    s_add_u32 m0, s74, 40960
    s_add_u32 s11, s15, 0
    buffer_load_dwordx4 v3, s[56:59], s11 offen lds
    s_add_u32 m0, s74, 41984
    s_add_u32 s11, s15, 28672
    buffer_load_dwordx4 v12, s[56:59], s11 offen lds
    s_and_b32 s12, s10, 1
    v_lshlrev_b32 v6, 4, v0
    v_add_u32 v8, s70, v6
    s_mul_i32 s14, s10, 448
    v_add_u32 v15, s14, v24
    v_mul_u32_u24 v9, 896, v15
    v_lshl_add_u32 v9, v19, 4, v9
    s_lshl_b32 s14, s9, 7
    v_add_u32 v9, s14, v9
    v_and_b32 v16, 3, v0
    s_mov_b32 s71, 0xffff0000
    s_mov_b32 s64, s46
    s_and_b32 s65, s47, 0xffff
    s_mov_b32 s66, 0x1000000
    s_mov_b32 s67, 0x20000
    s_mov_b64 s[38:39], s[32:33]
    s_mov_b32 s32, s40
    s_and_b32 s33, s41, 0xffff
    s_mov_b32 s34, 0x188000
    s_mov_b32 s35, 0x20000
    s_lshl_b32 s11, s9, 2
    s_lshr_b32 s13, 0x0, s11
    s_and_b32 s13, s13, 15
    s_and_b32 s11, s5, 3
    s_lshl_b32 s11, s11, 1
    s_add_u32 s11, s11, s13
    s_cmp_ge_u32 s11, 7
    s_cselect_b32 s13, 7, 0
    s_sub_u32 s14, s11, s13
    s_mov_b32 s16, 0
    s_mov_b32 s17, 0
    s_lshl_b32 s11, s8, 1
    s_add_u32 s40, s11, s12
    s_lshl_b32 s12, s40, 5
    v_lshrrev_b32 v15, 2, v0
    v_add_u32 v15, s12, v15
    v_mul_u32_u24 v15, 896, v15
    v_lshl_add_u32 v20, v16, 4, v15
    v_lshrrev_b32 v17, 5, v0
    v_lshl_add_u32 v15, v17, 4, s12
    s_lshr_b32 s13, s10, 1
    s_lshl_b32 s12, s13, 5
    s_lshl_b32 s11, s9, 6
    s_add_u32 s11, s11, s12
    s_lshl_b32 s41, s11, 1
    v_and_b32 v18, 31, v0
    v_add_u32 v16, s11, v18
    v_mul_u32_u24 v15, 448, v15
    v_add_lshl_u32 v7, v15, v16, 2
    v_lshlrev_b32 v21, 1, v16
    s_lshl_b32 s12, s13, 10
    v_add_u32 v10, s12, v6
    v_xor_b32 v11, 1024, v10
    s_lshl_b32 s11, s9, 1
    s_add_u32 s11, s11, s13
    s_mul_i32 s11, s11, 57344
    s_add_u32 s11, s11, 0xb20000
    s_and_b32 s12, s10, 1
    s_lshl_b32 s16, s12, 15
    s_add_u32 s16, s16, s11
    s_lshl_b32 s17, s12, 12
    s_add_u32 s17, s17, s11
    s_add_u32 s17, s17, 24576
    s_lshl_b32 s21, s7, 7
    s_mul_i32 s22, s6, 3584
    s_add_u32 s22, s22, s21
    s_add_u32 s22, s22, 0xadc360
    s_mov_b32 s23, 0xb04000
    s_mov_b32 s20, 0xb07800
    s_lshl_b32 s18, s8, 10
    s_and_b32 s11, s10, 1
    s_lshl_b32 s11, s11, 7
    s_add_u32 s18, s18, s11
    s_add_u32 s18, s18, 0xb0c200
    s_lshl_b32 s11, s6, 2
    s_add_u32 s11, s11, s10
    s_mul_i32 s19, s11, 344064
    s_lshl_b32 s11, s7, 10
    s_add_u32 s19, s19, s11
    s_add_u32 s19, s19, 57344
    s_add_u32 s12, s14, 0
    s_cmp_ge_u32 s12, 7
    s_cselect_b32 s13, 7, 0
    s_sub_u32 s12, s12, s13
    s_mul_i32 s28, s12, 57344
    s_add_u32 s12, s14, 1
    s_cmp_ge_u32 s12, 7
    s_cselect_b32 s13, 7, 0
    s_sub_u32 s12, s12, s13
    s_mul_i32 s29, s12, 57344
    s_add_u32 s12, s14, 2
    s_cmp_ge_u32 s12, 7
    s_cselect_b32 s13, 7, 0
    s_sub_u32 s12, s12, s13
    s_mul_i32 s30, s12, 57344
    s_add_u32 s12, s14, 3
    s_cmp_ge_u32 s12, 7
    s_cselect_b32 s13, 7, 0
    s_sub_u32 s12, s12, s13
    s_mul_i32 s31, s12, 57344
    s_add_u32 s12, s14, 4
    s_cmp_ge_u32 s12, 7
    s_cselect_b32 s13, 7, 0
    s_sub_u32 s12, s12, s13
    s_mul_i32 s36, s12, 57344
    s_add_u32 s12, s14, 5
    s_cmp_ge_u32 s12, 7
    s_cselect_b32 s13, 7, 0
    s_sub_u32 s12, s12, s13
    s_mul_i32 s37, s12, 57344
    s_add_u32 s12, s14, 6
    s_cmp_ge_u32 s12, 7
    s_cselect_b32 s13, 7, 0
    s_sub_u32 s12, s12, s13
    s_mul_i32 s21, s12, 57344
    s_add_u32 s11, s72, 106496
    v_add_u32 v19, s11, v6
    s_add_u32 m0, s72, 4096
    s_add_u32 s11, s69, 28672
    buffer_load_dwordx4 v1, s[48:51], s11 offen lds
    s_add_u32 m0, s72, 5120
    s_add_u32 s11, s69, 32256
    buffer_load_dwordx4 v2, s[48:51], s11 offen lds
    s_add_u32 m0, s72, 6144
    s_add_u32 s11, s69, 35840
    buffer_load_dwordx4 v1, s[48:51], s11 offen lds
    s_add_u32 m0, s72, 7168
    s_add_u32 s11, s69, 39424
    buffer_load_dwordx4 v2, s[48:51], s11 offen lds
    s_add_u32 m0, s75, 49152
    s_add_u32 s11, s69, 0
    buffer_load_dwordx4 v4, s[60:63], s11 offen lds
    s_bfe_u32 s69, s68, 0x40004
    s_mul_i32 s15, s69, 229376
    s_lshl_b32 s69, s69, 7
    s_add_u32 m0, s74, 86016
    s_add_u32 s11, s15, 0
    buffer_load_dwordx4 v3, s[52:55], s11 offen lds
    s_add_u32 m0, s74, 87040
    s_add_u32 s11, s15, 28672
    buffer_load_dwordx4 v12, s[52:55], s11 offen lds
    s_add_u32 m0, s72, 53248
    s_add_u32 s11, s69, 0
    buffer_load_dwordx4 v1, s[48:51], s11 offen lds
    s_add_u32 m0, s72, 54272
    s_add_u32 s11, s69, 3584
    buffer_load_dwordx4 v2, s[48:51], s11 offen lds
    s_add_u32 m0, s72, 55296
    s_add_u32 s11, s69, 7168
    buffer_load_dwordx4 v1, s[48:51], s11 offen lds
    s_add_u32 m0, s72, 56320
    s_add_u32 s11, s69, 10752
    buffer_load_dwordx4 v2, s[48:51], s11 offen lds
    s_setprio 3
    s_waitcnt vmcnt(6)
    s_barrier
    ds_read_b128 v[216:219], v19 offset:0
    ds_read_b128 v[220:223], v19 offset:1024
    ds_read_b128 v[224:227], v19 offset:2048
    ds_read_b128 v[228:231], v19 offset:3072
    ds_read_b128 v[232:235], v19 offset:4096
    ds_read_b128 v[236:239], v19 offset:5120
    s_add_u32 m0, s74, 94208
    s_add_u32 s11, s15, 0
    buffer_load_dwordx4 v3, s[56:59], s11 offen lds
    s_add_u32 m0, s74, 95232
    s_add_u32 s11, s15, 28672
    buffer_load_dwordx4 v12, s[56:59], s11 offen lds
    s_add_u32 m0, s72, 57344
    s_add_u32 s11, s69, 28672
    buffer_load_dwordx4 v1, s[48:51], s11 offen lds
    s_add_u32 m0, s72, 58368
    s_add_u32 s11, s69, 32256
    buffer_load_dwordx4 v2, s[48:51], s11 offen lds
    s_add_u32 m0, s72, 59392
    s_add_u32 s11, s69, 35840
    buffer_load_dwordx4 v1, s[48:51], s11 offen lds
    s_add_u32 m0, s72, 60416
    s_add_u32 s11, s69, 39424
    buffer_load_dwordx4 v2, s[48:51], s11 offen lds
    s_add_u32 m0, s75, 102400
    s_add_u32 s11, s69, 0
    buffer_load_dwordx4 v4, s[60:63], s11 offen lds
    s_waitcnt lgkmcnt(0)
    s_bfe_u32 s69, s68, 0x40008
    s_mul_i32 s15, s69, 229376
    s_lshl_b32 s69, s69, 7
    s_add_u32 m0, s74, 139264
    s_add_u32 s11, s15, 0
    buffer_load_dwordx4 v3, s[52:55], s11 offen lds
    s_add_u32 m0, s74, 140288
    s_add_u32 s11, s15, 28672
    buffer_load_dwordx4 v12, s[52:55], s11 offen lds
    s_add_u32 m0, s72, 106496
    s_add_u32 s11, s69, 0
    buffer_load_dwordx4 v1, s[48:51], s11 offen lds
    s_add_u32 m0, s72, 107520
    s_add_u32 s11, s69, 3584
    buffer_load_dwordx4 v2, s[48:51], s11 offen lds
    s_add_u32 m0, s72, 108544
    s_add_u32 s11, s69, 7168
    buffer_load_dwordx4 v1, s[48:51], s11 offen lds
    s_add_u32 m0, s72, 109568
    s_add_u32 s11, s69, 10752
    buffer_load_dwordx4 v2, s[48:51], s11 offen lds
    s_add_u32 m0, s74, 147456
    s_add_u32 s11, s15, 0
    buffer_load_dwordx4 v3, s[56:59], s11 offen lds
    s_add_u32 m0, s74, 148480
    s_add_u32 s11, s15, 28672
    buffer_load_dwordx4 v12, s[56:59], s11 offen lds
    s_add_u32 m0, s72, 110592
    s_add_u32 s11, s69, 28672
    buffer_load_dwordx4 v1, s[48:51], s11 offen lds
    s_waitcnt vmcnt(9)
    s_barrier
    s_add_u32 m0, s72, 111616
    s_add_u32 s11, s69, 32256
    buffer_load_dwordx4 v2, s[48:51], s11 offen lds
    s_add_u32 m0, s72, 112640
    s_add_u32 s11, s69, 35840
    buffer_load_dwordx4 v1, s[48:51], s11 offen lds
    s_add_u32 m0, s72, 113664
    s_add_u32 s11, s69, 39424
    buffer_load_dwordx4 v2, s[48:51], s11 offen lds
    s_add_u32 m0, s75, 155648
    s_add_u32 s11, s69, 0
    buffer_load_dwordx4 v4, s[60:63], s11 offen lds
    s_bfe_u32 s69, s68, 0x4000c
    s_mul_i32 s15, s69, 229376
    s_lshl_b32 s69, s69, 7
    s_add_u32 m0, s74, 32768
    s_add_u32 s11, s15, 0
    buffer_load_dwordx4 v3, s[52:55], s11 offen lds
    s_add_u32 m0, s74, 33792
    s_add_u32 s11, s15, 28672
    buffer_load_dwordx4 v12, s[52:55], s11 offen lds
    s_add_u32 m0, s72, 0
    s_add_u32 s11, s69, 0
    buffer_load_dwordx4 v1, s[48:51], s11 offen lds
    s_add_u32 m0, s72, 1024
    s_add_u32 s11, s69, 3584
    buffer_load_dwordx4 v2, s[48:51], s11 offen lds
    s_add_u32 m0, s72, 2048
    s_add_u32 s11, s69, 7168
    buffer_load_dwordx4 v1, s[48:51], s11 offen lds
    s_add_u32 m0, s72, 3072
    s_add_u32 s11, s69, 10752
    buffer_load_dwordx4 v2, s[48:51], s11 offen lds
    s_add_u32 m0, s74, 40960
    s_add_u32 s11, s15, 0
    buffer_load_dwordx4 v3, s[56:59], s11 offen lds
    s_add_u32 m0, s74, 41984
    s_add_u32 s11, s15, 28672
    buffer_load_dwordx4 v12, s[56:59], s11 offen lds
    s_add_u32 m0, s72, 4096
    s_add_u32 s11, s69, 28672
    buffer_load_dwordx4 v1, s[48:51], s11 offen lds
    s_add_u32 m0, s72, 5120
    s_add_u32 s11, s69, 32256
    buffer_load_dwordx4 v2, s[48:51], s11 offen lds
    s_add_u32 m0, s72, 6144
    s_add_u32 s11, s69, 35840
    buffer_load_dwordx4 v1, s[48:51], s11 offen lds
    s_add_u32 m0, s72, 7168
    s_add_u32 s11, s69, 39424
    buffer_load_dwordx4 v2, s[48:51], s11 offen lds
    s_add_u32 m0, s75, 49152
    s_add_u32 s11, s69, 0
    buffer_load_dwordx4 v4, s[60:63], s11 offen lds
    s_add_u32 s12, s41, 14336
    buffer_load_dwordx4 v[208:211], v20, s[48:51], s41 offen
    buffer_load_dwordx4 v[212:215], v20, s[48:51], s12 offen
    global_load_ushort v239, v21, s[38:39]
    s_waitcnt vmcnt(16)
    s_barrier
    s_bfe_u32 s69, s68, 0x40010
    s_mul_i32 s15, s69, 229376
    s_lshl_b32 s69, s69, 7
    s_add_u32 m0, s74, 86016
    s_add_u32 s11, s15, 0
    buffer_load_dwordx4 v3, s[52:55], s11 offen lds
    s_add_u32 m0, s74, 87040
    s_add_u32 s11, s15, 28672
    buffer_load_dwordx4 v12, s[52:55], s11 offen lds
    s_add_u32 m0, s72, 53248
    s_add_u32 s11, s69, 0
    buffer_load_dwordx4 v1, s[48:51], s11 offen lds
    s_add_u32 m0, s72, 54272
    s_add_u32 s11, s69, 3584
    buffer_load_dwordx4 v2, s[48:51], s11 offen lds
    s_add_u32 m0, s72, 55296
    s_add_u32 s11, s69, 7168
    buffer_load_dwordx4 v1, s[48:51], s11 offen lds
    s_add_u32 m0, s72, 56320
    s_add_u32 s11, s69, 10752
    buffer_load_dwordx4 v2, s[48:51], s11 offen lds
    s_add_u32 m0, s74, 94208
    s_add_u32 s11, s15, 0
    buffer_load_dwordx4 v3, s[56:59], s11 offen lds
    s_add_u32 m0, s74, 95232
    s_add_u32 s11, s15, 28672
    buffer_load_dwordx4 v12, s[56:59], s11 offen lds
    s_add_u32 m0, s72, 57344
    s_add_u32 s11, s69, 28672
    buffer_load_dwordx4 v1, s[48:51], s11 offen lds
    s_add_u32 m0, s72, 58368
    s_add_u32 s11, s69, 32256
    buffer_load_dwordx4 v2, s[48:51], s11 offen lds
    s_add_u32 m0, s72, 59392
    s_add_u32 s11, s69, 35840
    buffer_load_dwordx4 v1, s[48:51], s11 offen lds
    s_add_u32 m0, s72, 60416
    s_add_u32 s11, s69, 39424
    buffer_load_dwordx4 v2, s[48:51], s11 offen lds
    s_add_u32 m0, s75, 102400
    s_add_u32 s11, s69, 0
    buffer_load_dwordx4 v4, s[60:63], s11 offen lds
    s_add_u32 s11, s31, 0
    buffer_load_dwordx4 v[64:67], v9, s[32:35], s11 offen
    s_add_u32 s11, s31, 14336
    buffer_load_dwordx4 v[68:71], v9, s[32:35], s11 offen
    s_add_u32 s11, s31, 7168
    buffer_load_dwordx4 v[72:75], v9, s[32:35], s11 offen
    s_add_u32 s11, s31, 21504
    buffer_load_dwordx4 v[76:79], v9, s[32:35], s11 offen
    s_add_u32 s11, s31, 28672
    buffer_load_dwordx4 v[80:83], v9, s[32:35], s11 offen
    s_add_u32 s11, s31, 43008
    buffer_load_dwordx4 v[84:87], v9, s[32:35], s11 offen
    s_waitcnt vmcnt(22)
    s_barrier
    s_bfe_u32 s69, s68, 0x40014
    s_mul_i32 s15, s69, 229376
    s_lshl_b32 s69, s69, 7
    s_add_u32 m0, s74, 139264
    s_add_u32 s11, s15, 0
    buffer_load_dwordx4 v3, s[52:55], s11 offen lds
    s_add_u32 m0, s74, 140288
    s_add_u32 s11, s15, 28672
    buffer_load_dwordx4 v12, s[52:55], s11 offen lds
    s_add_u32 m0, s72, 106496
    s_add_u32 s11, s69, 0
    buffer_load_dwordx4 v1, s[48:51], s11 offen lds
    s_add_u32 m0, s72, 107520
    s_add_u32 s11, s69, 3584
    buffer_load_dwordx4 v2, s[48:51], s11 offen lds
    s_add_u32 m0, s72, 108544
    s_add_u32 s11, s69, 7168
    buffer_load_dwordx4 v1, s[48:51], s11 offen lds
    s_add_u32 m0, s72, 109568
    s_add_u32 s11, s69, 10752
    buffer_load_dwordx4 v2, s[48:51], s11 offen lds
    s_add_u32 m0, s74, 147456
    s_add_u32 s11, s15, 0
    buffer_load_dwordx4 v3, s[56:59], s11 offen lds
    s_add_u32 m0, s74, 148480
    s_add_u32 s11, s15, 28672
    buffer_load_dwordx4 v12, s[56:59], s11 offen lds
    s_add_u32 m0, s72, 110592
    s_add_u32 s11, s69, 28672
    buffer_load_dwordx4 v1, s[48:51], s11 offen lds
    s_add_u32 m0, s72, 111616
    s_add_u32 s11, s69, 32256
    buffer_load_dwordx4 v2, s[48:51], s11 offen lds
    s_add_u32 m0, s72, 112640
    s_add_u32 s11, s69, 35840
    buffer_load_dwordx4 v1, s[48:51], s11 offen lds
    s_add_u32 m0, s72, 113664
    s_add_u32 s11, s69, 39424
    buffer_load_dwordx4 v2, s[48:51], s11 offen lds
    s_add_u32 m0, s75, 155648
    s_add_u32 s11, s69, 0
    buffer_load_dwordx4 v4, s[60:63], s11 offen lds
    s_add_u32 s11, s31, 35840
    buffer_load_dwordx4 v[88:91], v9, s[32:35], s11 offen
    s_add_u32 s11, s31, 50176
    buffer_load_dwordx4 v[92:95], v9, s[32:35], s11 offen
    s_add_u32 s11, s36, 0
    buffer_load_dwordx4 v[96:99], v9, s[32:35], s11 offen
    s_add_u32 s11, s36, 14336
    buffer_load_dwordx4 v[100:103], v9, s[32:35], s11 offen
    s_add_u32 s11, s36, 7168
    buffer_load_dwordx4 v[104:107], v9, s[32:35], s11 offen
    s_add_u32 s11, s36, 21504
    buffer_load_dwordx4 v[108:111], v9, s[32:35], s11 offen
    s_waitcnt vmcnt(25)
    s_barrier
    v_mov_b32 v26, 0
    global_load_dword v5, v26, s[44:45] sc1
    s_bfe_u32 s69, s68, 0x40018
    s_mul_i32 s15, s69, 229376
    s_lshl_b32 s69, s69, 7
    s_add_u32 m0, s74, 32768
    s_add_u32 s11, s15, 0
    buffer_load_dwordx4 v3, s[52:55], s11 offen lds
    s_add_u32 m0, s74, 33792
    s_add_u32 s11, s15, 28672
    buffer_load_dwordx4 v12, s[52:55], s11 offen lds
    s_add_u32 m0, s72, 0
    s_add_u32 s11, s69, 0
    buffer_load_dwordx4 v1, s[48:51], s11 offen lds
    s_add_u32 m0, s72, 1024
    s_add_u32 s11, s69, 3584
    buffer_load_dwordx4 v2, s[48:51], s11 offen lds
    s_add_u32 m0, s72, 2048
    s_add_u32 s11, s69, 7168
    buffer_load_dwordx4 v1, s[48:51], s11 offen lds
    s_add_u32 m0, s72, 3072
    s_add_u32 s11, s69, 10752
    buffer_load_dwordx4 v2, s[48:51], s11 offen lds
    s_add_u32 m0, s74, 40960
    s_add_u32 s11, s15, 0
    buffer_load_dwordx4 v3, s[56:59], s11 offen lds
    s_add_u32 m0, s74, 41984
    s_add_u32 s11, s15, 28672
    buffer_load_dwordx4 v12, s[56:59], s11 offen lds
    s_add_u32 m0, s72, 4096
    s_add_u32 s11, s69, 28672
    buffer_load_dwordx4 v1, s[48:51], s11 offen lds
    s_add_u32 m0, s72, 5120
    s_add_u32 s11, s69, 32256
    buffer_load_dwordx4 v2, s[48:51], s11 offen lds
    s_add_u32 m0, s72, 6144
    s_add_u32 s11, s69, 35840
    buffer_load_dwordx4 v1, s[48:51], s11 offen lds
    s_add_u32 m0, s72, 7168
    s_add_u32 s11, s69, 39424
    buffer_load_dwordx4 v2, s[48:51], s11 offen lds
    s_add_u32 m0, s75, 49152
    s_add_u32 s11, s69, 0
    buffer_load_dwordx4 v4, s[60:63], s11 offen lds
    s_add_u32 s11, s36, 28672
    buffer_load_dwordx4 v[112:115], v9, s[32:35], s11 offen
    s_add_u32 s11, s36, 43008
    buffer_load_dwordx4 v[116:119], v9, s[32:35], s11 offen
    s_add_u32 s11, s36, 35840
    buffer_load_dwordx4 v[120:123], v9, s[32:35], s11 offen
    s_add_u32 s11, s36, 50176
    buffer_load_dwordx4 v[124:127], v9, s[32:35], s11 offen
    s_waitcnt vmcnt(24)
    s_barrier
    s_waitcnt vmcnt(17)
    s_mov_b32 s73, 0
L_init_spin_1:
    v_readfirstlane_b32 s11, v5
    s_nop 0
    s_cmp_ge_u32 s11, 32
    s_cbranch_scc1 L_init_ok_2
    s_add_u32 s73, s73, 1
    s_cmp_ge_u32 s73, 1048576
    s_cbranch_scc1 L_init_ok_2
    s_sleep 8
    global_load_dword v5, v26, s[44:45] sc1
    s_waitcnt vmcnt(0)
    s_branch L_init_spin_1
L_init_ok_2:
    s_nop 4
    s_lshl_b32 s11, s6, 8
    s_lshl_b32 s12, s10, 6
    s_add_u32 s11, s11, s12
    v_add_lshl_u32 v5, v0, s11, 3
    s_lshl_b32 s12, s8, 6
    v_add_lshl_u32 v26, v0, s12, 3
    s_mov_b32 s11, 0xb00000
    buffer_load_dwordx2 v[20:21], v5, s[64:67], s11 offen sc1
    buffer_load_dwordx2 v[22:23], v26, s[64:67], s11 offen sc1
    s_add_u32 m0, s70, 53248
    s_add_u32 s11, s28, 0
    buffer_load_dwordx4 v9, s[32:35], s11 offen lds
    s_add_u32 m0, s70, 54272
    s_add_u32 s11, s28, 14336
    buffer_load_dwordx4 v9, s[32:35], s11 offen lds
    s_add_u32 m0, s70, 55296
    s_add_u32 s11, s28, 7168
    buffer_load_dwordx4 v9, s[32:35], s11 offen lds
    s_add_u32 m0, s70, 56320
    s_add_u32 s11, s28, 21504
    buffer_load_dwordx4 v9, s[32:35], s11 offen lds
    s_add_u32 m0, s70, 57344
    s_add_u32 s11, s28, 28672
    buffer_load_dwordx4 v9, s[32:35], s11 offen lds
    s_add_u32 m0, s70, 58368
    s_add_u32 s11, s28, 43008
    buffer_load_dwordx4 v9, s[32:35], s11 offen lds
    s_add_u32 m0, s70, 59392
    s_add_u32 s11, s28, 35840
    buffer_load_dwordx4 v9, s[32:35], s11 offen lds
    s_add_u32 m0, s70, 60416
    s_add_u32 s11, s28, 50176
    buffer_load_dwordx4 v9, s[32:35], s11 offen lds
    s_add_u32 m0, s70, 61440
    s_add_u32 s11, s29, 0
    buffer_load_dwordx4 v9, s[32:35], s11 offen lds
    s_add_u32 m0, s70, 62464
    s_add_u32 s11, s29, 14336
    buffer_load_dwordx4 v9, s[32:35], s11 offen lds
    s_add_u32 m0, s70, 63488
    s_add_u32 s11, s29, 7168
    buffer_load_dwordx4 v9, s[32:35], s11 offen lds
    s_add_u32 m0, s70, 64512
    s_add_u32 s11, s29, 21504
    buffer_load_dwordx4 v9, s[32:35], s11 offen lds
    s_add_u32 s11, s37, 0
    buffer_load_dwordx4 v[128:131], v9, s[32:35], s11 offen
    s_add_u32 s11, s37, 14336
    buffer_load_dwordx4 v[132:135], v9, s[32:35], s11 offen
    s_add_u32 s11, s37, 7168
    buffer_load_dwordx4 v[136:139], v9, s[32:35], s11 offen
    s_add_u32 s11, s37, 21504
    buffer_load_dwordx4 v[140:143], v9, s[32:35], s11 offen
    s_add_u32 s11, s17, 0
    buffer_load_dwordx4 v[240:243], v10, s[64:67], s11 offen sc1
    s_add_u32 s11, s17, 0
    buffer_load_dwordx4 v[244:247], v11, s[64:67], s11 offen sc1
    s_add_u32 s11, s17, 2048
    buffer_load_dwordx4 v[248:251], v10, s[64:67], s11 offen sc1
    s_add_u32 s11, s17, 2048
    buffer_load_dwordx4 v[252:255], v11, s[64:67], s11 offen sc1
    s_waitcnt vmcnt(20)
    s_lshl_b32 s11, s10, 9
    s_add_u32 s11, s11, 159744
    v_lshl_add_u32 v19, v0, 3, s11
    ds_write_b64 v19, v[20:21]
    v_lshlrev_b32 v19, 3, v0
    v_add_u32 v19, 162464, v19
    ds_write_b64 v19, v[22:23]
    s_waitcnt lgkmcnt(0)
    s_barrier
    s_add_u32 m0, s70, 106496
    s_add_u32 s11, s29, 28672
    buffer_load_dwordx4 v9, s[32:35], s11 offen lds
    s_add_u32 m0, s70, 107520
    s_add_u32 s11, s29, 43008
    buffer_load_dwordx4 v9, s[32:35], s11 offen lds
    s_waitcnt lgkmcnt(0)
    s_barrier
    s_setprio 0
    s_add_u32 m0, s70, 108544
    s_add_u32 s11, s29, 35840
    buffer_load_dwordx4 v9, s[32:35], s11 offen lds
    s_add_u32 m0, s70, 109568
    s_add_u32 s11, s29, 50176
    buffer_load_dwordx4 v9, s[32:35], s11 offen lds
    s_add_u32 m0, s70, 110592
    s_add_u32 s11, s30, 0
    buffer_load_dwordx4 v9, s[32:35], s11 offen lds
    s_add_u32 m0, s70, 111616
    s_add_u32 s11, s30, 14336
    buffer_load_dwordx4 v9, s[32:35], s11 offen lds
    s_add_u32 m0, s70, 112640
    s_add_u32 s11, s30, 7168
    buffer_load_dwordx4 v9, s[32:35], s11 offen lds
    s_add_u32 m0, s70, 113664
    s_add_u32 s11, s30, 21504
    buffer_load_dwordx4 v9, s[32:35], s11 offen lds
    s_add_u32 m0, s70, 114688
    s_add_u32 s11, s30, 28672
    buffer_load_dwordx4 v9, s[32:35], s11 offen lds
    s_add_u32 m0, s70, 115712
    s_add_u32 s11, s30, 43008
    buffer_load_dwordx4 v9, s[32:35], s11 offen lds
    s_add_u32 m0, s70, 116736
    s_add_u32 s11, s30, 35840
    buffer_load_dwordx4 v9, s[32:35], s11 offen lds
    s_add_u32 m0, s70, 117760
    s_add_u32 s11, s30, 50176
    buffer_load_dwordx4 v9, s[32:35], s11 offen lds
    s_add_u32 s11, s16, 8192
    buffer_load_dwordx4 v[176:179], v10, s[64:67], s11 offen sc1
    s_add_u32 s11, s16, 8192
    buffer_load_dwordx4 v[180:183], v11, s[64:67], s11 offen sc1
    s_add_u32 s11, s16, 10240
    buffer_load_dwordx4 v[184:187], v10, s[64:67], s11 offen sc1
    s_add_u32 s11, s16, 10240
    buffer_load_dwordx4 v[188:191], v11, s[64:67], s11 offen sc1
    s_add_u32 s11, s16, 12288
    buffer_load_dwordx4 v[192:195], v10, s[64:67], s11 offen sc1
    s_add_u32 s11, s16, 12288
    buffer_load_dwordx4 v[196:199], v11, s[64:67], s11 offen sc1
    s_add_u32 s11, s16, 14336
    buffer_load_dwordx4 v[200:203], v10, s[64:67], s11 offen sc1
    s_add_u32 s11, s16, 14336
    buffer_load_dwordx4 v[204:207], v11, s[64:67], s11 offen sc1
    s_barrier
    v_bfe_u32 v15, v0, 4, 1
    v_lshlrev_b32 v17, 11, v15
    v_lshrrev_b32 v15, 5, v0
    v_lshl_add_u32 v17, v15, 8, v17
    v_and_b32 v15, 15, v0
    v_lshl_add_u32 v17, v15, 4, v17
    s_add_u32 s11, s70, 0
    v_add_u32 v17, s11, v17
    s_waitcnt vmcnt(8) lgkmcnt(0)
    s_barrier
    ds_read_b128 v[32:35], v17 offset:0
    ds_read_b128 v[36:39], v17 offset:512
    ds_read_b128 v[40:43], v17 offset:1024
    ds_read_b128 v[44:47], v17 offset:1536
    ds_read_b128 v[48:51], v17 offset:4096
    ds_read_b128 v[52:55], v17 offset:4608
    ds_read_b128 v[56:59], v17 offset:5120
    ds_read_b128 v[60:63], v17 offset:5632
    ds_read_b32 v24, v234
    ds_read_b32 v25, v234 offset:64
    ds_read_b128 v[144:147], v235 offset:0
    ds_read_b128 v[148:151], v235 offset:16
    ds_read_b128 v[152:155], v235 offset:32
    ds_read_b128 v[156:159], v235 offset:48
    ds_read_b128 v[160:163], v235 offset:64
    ds_read_b128 v[164:167], v235 offset:80
    ds_read_b128 v[168:171], v235 offset:96
    ds_read_b128 v[172:175], v235 offset:112
    s_setprio 0
    v_lshrrev_b32 v1, 4, v0
    v_sub_u32 v1, s6, v1
    v_cmp_le_i32 s[56:57], 1, v1
    v_cmp_le_i32 s[58:59], 5, v1
    v_lshlrev_b32 v5, 16, v239
    v_mov_b32 v3, v238
    s_waitcnt lgkmcnt(0)
    v_fma_f32 v32, -v144, v24, v32
    v_fma_f32 v48, -v144, v25, v48
    v_mul_f32 v32, v32, v145
    v_mul_f32 v48, v48, v145
    v_fma_f32 v33, -v146, v24, v33
    v_fma_f32 v49, -v146, v25, v49
    v_mul_f32 v33, v33, v147
    v_mul_f32 v49, v49, v147
    v_fma_f32 v22, -v217, v48, v33
    v_fma_f32 v23, v217, v32, v49
    v_fma_f32 v20, v216, v32, v22
    v_fma_f32 v21, v216, v48, v23
    v_fma_f32 v34, -v148, v24, v34
    v_fma_f32 v50, -v148, v25, v50
    v_mul_f32 v34, v34, v149
    v_mul_f32 v50, v50, v149
    v_fma_f32 v22, -v217, v21, v34
    v_fma_f32 v23, v217, v20, v50
    v_fma_f32 v20, v216, v20, v22
    v_fma_f32 v21, v216, v21, v23
    v_fma_f32 v35, -v150, v24, v35
    v_fma_f32 v51, -v150, v25, v51
    v_mul_f32 v35, v35, v151
    v_mul_f32 v51, v51, v151
    v_fma_f32 v22, -v217, v21, v35
    v_fma_f32 v23, v217, v20, v51
    v_fma_f32 v20, v216, v20, v22
    v_fma_f32 v21, v216, v21, v23
    v_fma_f32 v36, -v152, v24, v36
    v_fma_f32 v52, -v152, v25, v52
    v_mul_f32 v36, v36, v153
    v_mul_f32 v52, v52, v153
    v_fma_f32 v22, -v217, v21, v36
    v_fma_f32 v23, v217, v20, v52
    v_fma_f32 v20, v216, v20, v22
    v_fma_f32 v21, v216, v21, v23
    v_fma_f32 v37, -v154, v24, v37
    v_fma_f32 v53, -v154, v25, v53
    v_mul_f32 v37, v37, v155
    v_mul_f32 v53, v53, v155
    v_fma_f32 v22, -v217, v21, v37
    v_fma_f32 v23, v217, v20, v53
    v_fma_f32 v20, v216, v20, v22
    v_fma_f32 v21, v216, v21, v23
    v_fma_f32 v38, -v156, v24, v38
    v_fma_f32 v54, -v156, v25, v54
    v_mul_f32 v38, v38, v157
    v_mul_f32 v54, v54, v157
    v_fma_f32 v22, -v217, v21, v38
    v_fma_f32 v23, v217, v20, v54
    v_fma_f32 v20, v216, v20, v22
    v_fma_f32 v21, v216, v21, v23
    v_fma_f32 v39, -v158, v24, v39
    v_fma_f32 v55, -v158, v25, v55
    v_mul_f32 v39, v39, v159
    v_mul_f32 v55, v55, v159
    v_fma_f32 v22, -v217, v21, v39
    v_fma_f32 v23, v217, v20, v55
    v_fma_f32 v20, v216, v20, v22
    v_fma_f32 v21, v216, v21, v23
    v_fma_f32 v40, -v160, v24, v40
    v_fma_f32 v56, -v160, v25, v56
    v_mul_f32 v40, v40, v161
    v_mul_f32 v56, v56, v161
    v_fma_f32 v22, -v217, v21, v40
    v_fma_f32 v23, v217, v20, v56
    v_fma_f32 v20, v216, v20, v22
    v_fma_f32 v21, v216, v21, v23
    v_fma_f32 v41, -v162, v24, v41
    v_fma_f32 v57, -v162, v25, v57
    v_mul_f32 v41, v41, v163
    v_mul_f32 v57, v57, v163
    v_fma_f32 v22, -v217, v21, v41
    v_fma_f32 v23, v217, v20, v57
    v_fma_f32 v20, v216, v20, v22
    v_fma_f32 v21, v216, v21, v23
    v_fma_f32 v42, -v164, v24, v42
    v_fma_f32 v58, -v164, v25, v58
    v_mul_f32 v42, v42, v165
    v_mul_f32 v58, v58, v165
    v_fma_f32 v22, -v217, v21, v42
    v_fma_f32 v23, v217, v20, v58
    v_fma_f32 v20, v216, v20, v22
    v_fma_f32 v21, v216, v21, v23
    v_fma_f32 v43, -v166, v24, v43
    v_fma_f32 v59, -v166, v25, v59
    v_mul_f32 v43, v43, v167
    v_mul_f32 v59, v59, v167
    v_fma_f32 v22, -v217, v21, v43
    v_fma_f32 v23, v217, v20, v59
    v_fma_f32 v20, v216, v20, v22
    v_fma_f32 v21, v216, v21, v23
    v_fma_f32 v44, -v168, v24, v44
    v_fma_f32 v60, -v168, v25, v60
    v_mul_f32 v44, v44, v169
    v_mul_f32 v60, v60, v169
    v_fma_f32 v22, -v217, v21, v44
    v_fma_f32 v23, v217, v20, v60
    v_fma_f32 v20, v216, v20, v22
    v_fma_f32 v21, v216, v21, v23
    v_fma_f32 v45, -v170, v24, v45
    v_fma_f32 v61, -v170, v25, v61
    v_mul_f32 v45, v45, v171
    v_mul_f32 v61, v61, v171
    v_fma_f32 v22, -v217, v21, v45
    v_fma_f32 v23, v217, v20, v61
    v_fma_f32 v20, v216, v20, v22
    v_fma_f32 v21, v216, v21, v23
    v_fma_f32 v46, -v172, v24, v46
    v_fma_f32 v62, -v172, v25, v62
    v_mul_f32 v46, v46, v173
    v_mul_f32 v62, v62, v173
    v_fma_f32 v22, -v217, v21, v46
    v_fma_f32 v23, v217, v20, v62
    v_fma_f32 v20, v216, v20, v22
    v_fma_f32 v21, v216, v21, v23
    v_fma_f32 v47, -v174, v24, v47
    v_fma_f32 v63, -v174, v25, v63
    v_mul_f32 v47, v47, v175
    v_mul_f32 v63, v63, v175
    v_fma_f32 v22, -v217, v21, v47
    v_fma_f32 v23, v217, v20, v63
    v_fma_f32 v20, v216, v20, v22
    v_fma_f32 v21, v216, v21, v23
    v_mov_b32 v144, v20
    v_mov_b32 v145, v21
    v_mul_f32 v154, v221, v221
    v_add_f32 v153, v221, v221
    v_mul_f32 v153, v153, v220
    v_fma_f32 v152, v220, v220, -v154
    v_permlane32_swap_b32 v20, v144
    v_permlane32_swap_b32 v21, v145
    v_fma_f32 v144, -v221, v21, v144
    v_fma_f32 v145, v221, v20, v145
    v_fmac_f32 v144, v220, v20
    v_fmac_f32 v145, v220, v21
    v_mov_b32 v146, v144
    v_mov_b32 v147, v145
    s_lshl_b32 s11, s10, 7
    v_add_u32 v149, s11, v236
    v_permlane16_swap_b32 v144, v146
    v_permlane16_swap_b32 v145, v147
    v_fma_f32 v146, -v153, v145, v146
    v_fma_f32 v147, v153, v144, v147
    v_fmac_f32 v146, v152, v144
    v_fmac_f32 v147, v152, v145
    ds_write_b64 v149, v[146:147]
    s_waitcnt lgkmcnt(0)
    s_setprio 3
    s_barrier
    ds_read_b64 v[162:163], v236 offset:0
    ds_read_b64 v[164:165], v236 offset:128
    ds_read_b64 v[166:167], v236 offset:256
    ds_read_b64 v[168:169], v236 offset:384
    v_mov_b32 v160, 0
    v_mov_b32 v161, 0
    v_and_b32 v148, 16, v0
    v_cmp_ne_u32 s[12:13], 0, v148
    s_waitcnt lgkmcnt(2)
    v_fma_f32 v164, -v225, v163, v164
    v_fma_f32 v165, v225, v162, v165
    v_fmac_f32 v164, v224, v162
    v_fmac_f32 v165, v224, v163
    s_waitcnt lgkmcnt(1)
    v_fma_f32 v166, -v225, v165, v166
    v_fma_f32 v167, v225, v164, v167
    v_fmac_f32 v166, v224, v164
    v_fmac_f32 v167, v224, v165
    s_waitcnt lgkmcnt(0)
    v_fma_f32 v168, -v225, v167, v168
    v_fma_f32 v169, v225, v166, v169
    v_fmac_f32 v168, v224, v166
    v_fmac_f32 v169, v224, v167
    s_cmp_lg_u32 s10, 0
    s_cbranch_scc1 L_l_nopub
    v_cmp_eq_u32 vcc, -1, v168
    v_mov_b32 v22, 0x7fc00000
    s_nop 0
    v_cndmask_b32 v168, v168, v22, vcc
    s_mov_b64 exec, 0xffff
    buffer_store_dwordx2 v[168:169], v236, s[64:67], s22 offen sc1
    s_mov_b64 exec, -1
L_l_nopub:
    v_cmp_lt_u32 vcc, 31, v0
    s_nop 1
    v_cndmask_b32 v144, 0, v144, s[12:13]
    v_cndmask_b32 v145, 0, v145, s[12:13]
    v_fma_f32 v20, -v221, v145, v20
    v_fma_f32 v21, v221, v144, v21
    v_fmac_f32 v20, v220, v144
    v_fmac_f32 v21, v220, v145
    v_cndmask_b32 v144, v144, v20, vcc
    v_cndmask_b32 v145, v145, v21, vcc
    v_mul_f32 v20, v144, v218
    v_mul_f32 v21, v144, v219
    v_fma_f32 v20, -v145, v219, v20
    v_fma_f32 v21, v145, v218, v21
    s_bitcmp1_b32 s10, 0
    s_cselect_b64 vcc, -1, 0
    v_cndmask_b32 v30, v160, v162, vcc
    v_cndmask_b32 v31, v161, v163, vcc
    v_cndmask_b32 v22, v164, v166, vcc
    v_cndmask_b32 v23, v165, v167, vcc
    s_bitcmp1_b32 s10, 1
    s_cselect_b64 vcc, -1, 0
    v_cndmask_b32 v30, v30, v22, vcc
    v_cndmask_b32 v31, v31, v23, vcc
    s_lshl_b32 s11, s10, 2
    s_add_u32 s11, s11, 162448
    v_mov_b32 v4, s11
    v_mov_b32 v2, 1
    s_add_u32 m0, s70, 110592
    s_add_u32 s11, s37, 28672
    buffer_load_dwordx4 v9, s[32:35], s11 offen lds
    v_mul_f32 v22, v219, v48
    v_mul_f32 v23, v219, v32
    v_fma_f32 v32, v218, v32, -v22
    v_fma_f32 v48, v218, v48, v23
    s_add_u32 m0, s70, 111616
    s_add_u32 s11, s37, 43008
    buffer_load_dwordx4 v9, s[32:35], s11 offen lds
    v_mul_f32 v22, v219, v49
    v_mul_f32 v23, v219, v33
    v_fma_f32 v33, v218, v33, -v22
    v_fma_f32 v49, v218, v49, v23
    s_add_u32 m0, s70, 112640
    s_add_u32 s11, s37, 35840
    buffer_load_dwordx4 v9, s[32:35], s11 offen lds
    v_mul_f32 v22, v219, v50
    v_mul_f32 v23, v219, v34
    v_fma_f32 v34, v218, v34, -v22
    v_fma_f32 v50, v218, v50, v23
    s_add_u32 m0, s70, 113664
    s_add_u32 s11, s37, 50176
    buffer_load_dwordx4 v9, s[32:35], s11 offen lds
    v_mul_f32 v22, v219, v51
    v_mul_f32 v23, v219, v35
    v_fma_f32 v35, v218, v35, -v22
    v_fma_f32 v51, v218, v51, v23
    s_add_u32 m0, s70, 61440
    s_add_u32 s11, s21, 0
    buffer_load_dwordx4 v9, s[32:35], s11 offen lds
    v_mul_f32 v22, v219, v52
    v_mul_f32 v23, v219, v36
    v_fma_f32 v36, v218, v36, -v22
    v_fma_f32 v52, v218, v52, v23
    s_add_u32 m0, s70, 62464
    s_add_u32 s11, s21, 14336
    buffer_load_dwordx4 v9, s[32:35], s11 offen lds
    v_mul_f32 v22, v219, v53
    v_mul_f32 v23, v219, v37
    v_fma_f32 v37, v218, v37, -v22
    v_fma_f32 v53, v218, v53, v23
    s_add_u32 m0, s70, 63488
    s_add_u32 s11, s21, 7168
    buffer_load_dwordx4 v9, s[32:35], s11 offen lds
    v_mul_f32 v22, v219, v54
    v_mul_f32 v23, v219, v38
    v_fma_f32 v38, v218, v38, -v22
    v_fma_f32 v54, v218, v54, v23
    s_add_u32 m0, s70, 64512
    s_add_u32 s11, s21, 21504
    buffer_load_dwordx4 v9, s[32:35], s11 offen lds
    v_mul_f32 v22, v219, v55
    v_mul_f32 v23, v219, v39
    v_fma_f32 v39, v218, v39, -v22
    v_fma_f32 v55, v218, v55, v23
    s_add_u32 m0, s70, 114688
    s_add_u32 s11, s21, 28672
    buffer_load_dwordx4 v9, s[32:35], s11 offen lds
    v_mul_f32 v22, v219, v56
    v_mul_f32 v23, v219, v40
    v_fma_f32 v40, v218, v40, -v22
    v_fma_f32 v56, v218, v56, v23
    s_add_u32 m0, s70, 115712
    s_add_u32 s11, s21, 43008
    buffer_load_dwordx4 v9, s[32:35], s11 offen lds
    v_mul_f32 v22, v219, v57
    v_mul_f32 v23, v219, v41
    v_fma_f32 v41, v218, v41, -v22
    v_fma_f32 v57, v218, v57, v23
    s_add_u32 m0, s70, 116736
    s_add_u32 s11, s21, 35840
    buffer_load_dwordx4 v9, s[32:35], s11 offen lds
    v_mul_f32 v22, v219, v58
    v_mul_f32 v23, v219, v42
    v_fma_f32 v42, v218, v42, -v22
    v_fma_f32 v58, v218, v58, v23
    s_add_u32 m0, s70, 117760
    s_add_u32 s11, s21, 50176
    buffer_load_dwordx4 v9, s[32:35], s11 offen lds
    v_mul_f32 v22, v219, v59
    v_mul_f32 v23, v219, v43
    v_fma_f32 v43, v218, v43, -v22
    v_fma_f32 v59, v218, v59, v23
    v_mul_f32 v22, v219, v60
    v_mul_f32 v23, v219, v44
    v_fma_f32 v44, v218, v44, -v22
    v_fma_f32 v60, v218, v60, v23
    v_mul_f32 v22, v219, v61
    v_mul_f32 v23, v219, v45
    v_fma_f32 v45, v218, v45, -v22
    v_fma_f32 v61, v218, v61, v23
    v_mul_f32 v22, v219, v62
    v_mul_f32 v23, v219, v46
    v_fma_f32 v46, v218, v46, -v22
    v_fma_f32 v62, v218, v62, v23
    v_mul_f32 v22, v219, v63
    v_mul_f32 v23, v219, v47
    v_fma_f32 v47, v218, v47, -v22
    v_fma_f32 v63, v218, v63, v23
    buffer_load_dwordx2 v[26:27], v237, s[64:67], s23 offen sc1
    buffer_load_dwordx2 v[28:29], v237, s[64:67], s20 offen sc1
    v_add_u32 v19, 0, v8
    ds_write_b128 v19, v[64:67] offset:0
    ds_write_b128 v19, v[68:71] offset:1024
    ds_write_b128 v19, v[72:75] offset:2048
    ds_write_b128 v19, v[76:79] offset:3072
    ds_write_b128 v19, v[80:83] offset:4096
    ds_write_b128 v19, v[84:87] offset:5120
    ds_write_b128 v19, v[88:91] offset:6144
    ds_write_b128 v19, v[92:95] offset:7168
    ds_write_b32 v4, v2
    v_add_u32 v1, 8192, v8
    ds_write_b128 v1, v[208:211]
    ds_write_b128 v1, v[212:215] offset:1024
    v_lshrrev_b32 v18, 5, v0
    v_lshlrev_b32 v17, 10, v18
    v_and_b32 v15, 31, v0
    v_lshl_add_u32 v17, v15, 1, v17
    s_add_u32 s11, s70, 8192
    v_add_u32 v17, s11, v17
    ds_read_u16 v64, v17 offset:0
    ds_read_u16 v65, v17 offset:64
    ds_read_u16 v66, v17 offset:128
    ds_read_u16 v67, v17 offset:192
    ds_read_u16 v68, v17 offset:256
    ds_read_u16 v69, v17 offset:320
    ds_read_u16 v70, v17 offset:384
    ds_read_u16 v71, v17 offset:448
    ds_read_u16 v72, v17 offset:512
    ds_read_u16 v73, v17 offset:576
    ds_read_u16 v74, v17 offset:640
    ds_read_u16 v75, v17 offset:704
    ds_read_u16 v76, v17 offset:768
    ds_read_u16 v77, v17 offset:832
    ds_read_u16 v78, v17 offset:896
    ds_read_u16 v79, v17 offset:960
    v_add_u32 v19, 53248, v8
    ds_write_b128 v19, v[96:99] offset:0
    ds_write_b128 v19, v[100:103] offset:1024
    ds_write_b128 v19, v[104:107] offset:2048
    ds_write_b128 v19, v[108:111] offset:3072
    s_waitcnt vmcnt(0)
    s_mov_b32 s73, 0
L_agg_spin_3:
    v_cmp_eq_u32 vcc, -1, v26
    s_nop 0
    s_and_b64 s[48:49], vcc, s[56:57]
    v_cmp_eq_u32 vcc, -1, v28
    s_nop 0
    s_and_b64 s[50:51], vcc, s[58:59]
    s_or_b64 s[48:49], s[48:49], s[50:51]
    s_cmp_eq_u64 s[48:49], 0
    s_cbranch_scc1 L_agg_ok_4
    s_add_u32 s73, s73, 1
    s_cmp_ge_u32 s73, 1048576
    s_cbranch_scc1 L_agg_ok_4
    s_sleep 2
    buffer_load_dwordx2 v[26:27], v237, s[64:67], s23 offen sc1
    buffer_load_dwordx2 v[28:29], v237, s[64:67], s20 offen sc1
    s_waitcnt vmcnt(0)
    s_branch L_agg_spin_3
L_agg_ok_4:
    s_nop 4
    v_mul_f32 v24, v26, v228
    v_mul_f32 v25, v26, v229
    v_fma_f32 v24, -v27, v229, v24
    v_fma_f32 v25, v27, v228, v25
    v_mul_f32 v22, v28, v230
    v_mul_f32 v23, v28, v231
    v_fma_f32 v22, -v29, v231, v22
    v_fma_f32 v23, v29, v230, v23
    v_cndmask_b32 v24, 0, v24, s[56:57]
    v_cndmask_b32 v25, 0, v25, s[56:57]
    v_cndmask_b32 v22, 0, v22, s[58:59]
    v_cndmask_b32 v23, 0, v23, s[58:59]
    v_add_f32 v24, v24, v22
    v_add_f32 v25, v25, v23
    v_mov_b32 v22, v24
    v_mov_b32 v23, v25
    s_nop 0
    v_permlane32_swap_b32 v24, v22
    v_permlane32_swap_b32 v25, v23
    v_add_f32 v24, v24, v22
    v_add_f32 v25, v25, v23
    v_mov_b32 v22, v24
    v_mov_b32 v23, v25
    s_nop 0
    v_permlane16_swap_b32 v24, v22
    v_permlane16_swap_b32 v25, v23
    v_add_f32 v24, v24, v22
    v_add_f32 v25, v25, v23
    v_fmac_f32 v30, v226, v24
    v_fmac_f32 v31, v226, v25
    v_fma_f32 v30, -v227, v25, v30
    v_fmac_f32 v31, v227, v24
    v_fmac_f32 v20, v222, v30
    v_fmac_f32 v21, v222, v31
    v_fma_f32 v20, -v223, v31, v20
    v_fmac_f32 v21, v223, v30
    v_fma_f32 v32, -v217, v21, v32
    v_fma_f32 v48, v217, v20, v48
    v_fmac_f32 v32, v216, v20
    v_fmac_f32 v48, v216, v21
    v_fma_f32 v33, -v217, v48, v33
    v_fma_f32 v49, v217, v32, v49
    v_fmac_f32 v33, v216, v32
    v_fmac_f32 v49, v216, v48
    v_fma_f32 v34, -v217, v49, v34
    v_fma_f32 v50, v217, v33, v50
    v_fmac_f32 v34, v216, v33
    v_fmac_f32 v50, v216, v49
    v_fma_f32 v35, -v217, v50, v35
    v_fma_f32 v51, v217, v34, v51
    v_fmac_f32 v35, v216, v34
    v_fmac_f32 v51, v216, v50
    v_fma_f32 v36, -v217, v51, v36
    v_fma_f32 v52, v217, v35, v52
    v_fmac_f32 v36, v216, v35
    v_fmac_f32 v52, v216, v51
    v_fma_f32 v37, -v217, v52, v37
    v_fma_f32 v53, v217, v36, v53
    v_fmac_f32 v37, v216, v36
    v_fmac_f32 v53, v216, v52
    v_fma_f32 v38, -v217, v53, v38
    v_fma_f32 v54, v217, v37, v54
    v_fmac_f32 v38, v216, v37
    v_fmac_f32 v54, v216, v53
    v_fma_f32 v39, -v217, v54, v39
    v_fma_f32 v55, v217, v38, v55
    v_fmac_f32 v39, v216, v38
    v_fmac_f32 v55, v216, v54
    v_fma_f32 v40, -v217, v55, v40
    v_fma_f32 v56, v217, v39, v56
    v_fmac_f32 v40, v216, v39
    v_fmac_f32 v56, v216, v55
    v_fma_f32 v41, -v217, v56, v41
    v_fma_f32 v57, v217, v40, v57
    v_fmac_f32 v41, v216, v40
    v_fmac_f32 v57, v216, v56
    v_fma_f32 v42, -v217, v57, v42
    v_fma_f32 v58, v217, v41, v58
    v_fmac_f32 v42, v216, v41
    v_fmac_f32 v58, v216, v57
    v_fma_f32 v43, -v217, v58, v43
    v_fma_f32 v59, v217, v42, v59
    v_fmac_f32 v43, v216, v42
    v_fmac_f32 v59, v216, v58
    v_fma_f32 v44, -v217, v59, v44
    v_fma_f32 v60, v217, v43, v60
    v_fmac_f32 v44, v216, v43
    v_fmac_f32 v60, v216, v59
    v_fma_f32 v45, -v217, v60, v45
    v_fma_f32 v61, v217, v44, v61
    v_fmac_f32 v45, v216, v44
    v_fmac_f32 v61, v216, v60
    v_fma_f32 v46, -v217, v61, v46
    v_fma_f32 v62, v217, v45, v62
    v_fmac_f32 v46, v216, v45
    v_fmac_f32 v62, v216, v61
    v_fma_f32 v47, -v217, v62, v47
    v_fma_f32 v63, v217, v46, v63
    v_fmac_f32 v47, v216, v46
    v_fmac_f32 v63, v216, v62
    v_cvt_pk_bf16_f32 v96, v32, v33
    v_cvt_pk_bf16_f32 v97, v34, v35
    v_cvt_pk_bf16_f32 v98, v36, v37
    v_cvt_pk_bf16_f32 v99, v38, v39
    v_cvt_pk_bf16_f32 v100, v40, v41
    v_cvt_pk_bf16_f32 v101, v42, v43
    v_cvt_pk_bf16_f32 v102, v44, v45
    v_cvt_pk_bf16_f32 v103, v46, v47
    ds_write_b128 v232, v[96:99]
    ds_write_b128 v232, v[100:103] offset:16
    v_cvt_pk_bf16_f32 v104, -v48, -v49
    v_cvt_pk_bf16_f32 v105, -v50, -v51
    v_cvt_pk_bf16_f32 v106, -v52, -v53
    v_cvt_pk_bf16_f32 v107, -v54, -v55
    v_cvt_pk_bf16_f32 v108, -v56, -v57
    v_cvt_pk_bf16_f32 v109, -v58, -v59
    v_cvt_pk_bf16_f32 v110, -v60, -v61
    v_cvt_pk_bf16_f32 v111, -v62, -v63
    ds_write_b128 v232, v[104:107] offset:2048
    ds_write_b128 v232, v[108:111] offset:2064
    ds_read_b64_tr_b16 v[80:81], v233 offset:0
    ds_read_b64_tr_b16 v[82:83], v233 offset:576
    ds_read_b64_tr_b16 v[84:85], v233 offset:2048
    ds_read_b64_tr_b16 v[86:87], v233 offset:2624
    ds_read_b64_tr_b16 v[88:89], v233 offset:64
    ds_read_b64_tr_b16 v[90:91], v233 offset:512
    ds_read_b64_tr_b16 v[92:93], v233 offset:2112
    ds_read_b64_tr_b16 v[94:95], v233 offset:2560
    s_waitcnt lgkmcnt(0)
    s_add_u32 s11, s19, 0
    buffer_store_dwordx4 v[80:83], v6, s[64:67], s11 offen sc1
    s_add_u32 s11, s19, 86016
    buffer_store_dwordx4 v[84:87], v6, s[64:67], s11 offen sc1
    s_add_u32 s11, s19, 172032
    buffer_store_dwordx4 v[88:91], v6, s[64:67], s11 offen sc1
    s_add_u32 s11, s19, 258048
    buffer_store_dwordx4 v[92:95], v6, s[64:67], s11 offen sc1
    v_add_u32 v19, 57344, v8
    ds_write_b128 v19, v[112:115] offset:0
    ds_write_b128 v19, v[116:119] offset:1024
    ds_write_b128 v19, v[120:123] offset:2048
    ds_write_b128 v19, v[124:127] offset:3072
    v_add_u32 v19, 106496, v8
    ds_write_b128 v19, v[128:131] offset:0
    ds_write_b128 v19, v[132:135] offset:1024
    ds_write_b128 v19, v[136:139] offset:2048
    ds_write_b128 v19, v[140:143] offset:3072
    v_mov_b32 v22, 2
    ds_write_b32 v4, v22
    s_waitcnt vmcnt(0)
    s_mov_b64 exec, 1
    buffer_store_dword v2, v3, s[64:67], 0 offen sc1
    s_mov_b64 exec, -1
    s_and_b32 s11, s10, 1
    s_lshl_b32 s11, s11, 8
    s_add_u32 s11, s11, 162464
    v_lshl_add_u32 v18, v18, 7, s11
    ds_read_b128 v[32:35], v18 offset:0
    ds_read_b128 v[36:39], v18 offset:16
    ds_read_b128 v[40:43], v18 offset:32
    ds_read_b128 v[44:47], v18 offset:48
    ds_read_b128 v[48:51], v18 offset:64
    ds_read_b128 v[52:55], v18 offset:80
    ds_read_b128 v[56:59], v18 offset:96
    ds_read_b128 v[60:63], v18 offset:112
    v_lshlrev_b32 v64, 16, v64
    v_lshlrev_b32 v65, 16, v65
    v_lshlrev_b32 v66, 16, v66
    v_lshlrev_b32 v67, 16, v67
    v_lshlrev_b32 v68, 16, v68
    v_lshlrev_b32 v69, 16, v69
    v_lshlrev_b32 v70, 16, v70
    v_lshlrev_b32 v71, 16, v71
    v_lshlrev_b32 v72, 16, v72
    v_lshlrev_b32 v73, 16, v73
    v_lshlrev_b32 v74, 16, v74
    v_lshlrev_b32 v75, 16, v75
    v_lshlrev_b32 v76, 16, v76
    v_lshlrev_b32 v77, 16, v77
    v_lshlrev_b32 v78, 16, v78
    v_lshlrev_b32 v79, 16, v79
    s_waitcnt lgkmcnt(0)
    s_setprio 0
    v_sub_f32 v112, v64, v32
    v_sub_f32 v113, v65, v34
    v_sub_f32 v114, v66, v36
    v_sub_f32 v115, v67, v38
    v_sub_f32 v116, v68, v40
    v_sub_f32 v117, v69, v42
    v_sub_f32 v118, v70, v44
    v_sub_f32 v119, v71, v46
    v_sub_f32 v120, v72, v48
    v_sub_f32 v121, v73, v50
    v_sub_f32 v122, v74, v52
    v_sub_f32 v123, v75, v54
    v_sub_f32 v124, v76, v56
    v_sub_f32 v125, v77, v58
    v_sub_f32 v126, v78, v60
    v_sub_f32 v127, v79, v62
    v_cvt_pk_bf16_f32 v113, v112, v113
    v_lshlrev_b32 v112, 16, v113
    v_and_b32 v113, s71, v113
    v_cvt_pk_bf16_f32 v115, v114, v115
    v_lshlrev_b32 v114, 16, v115
    v_and_b32 v115, s71, v115
    v_cvt_pk_bf16_f32 v117, v116, v117
    v_lshlrev_b32 v116, 16, v117
    v_and_b32 v117, s71, v117
    v_cvt_pk_bf16_f32 v119, v118, v119
    v_lshlrev_b32 v118, 16, v119
    v_and_b32 v119, s71, v119
    v_cvt_pk_bf16_f32 v121, v120, v121
    v_lshlrev_b32 v120, 16, v121
    v_and_b32 v121, s71, v121
    v_cvt_pk_bf16_f32 v123, v122, v123
    v_lshlrev_b32 v122, 16, v123
    v_and_b32 v123, s71, v123
    v_cvt_pk_bf16_f32 v125, v124, v125
    v_lshlrev_b32 v124, 16, v125
    v_and_b32 v125, s71, v125
    v_cvt_pk_bf16_f32 v127, v126, v127
    v_lshlrev_b32 v126, 16, v127
    v_and_b32 v127, s71, v127
    v_mov_b32 v23, 3
    ds_write_b32 v4, v23
    v_mul_f32 v112, v112, v33
    v_mul_f32 v113, v113, v35
    v_mul_f32 v114, v114, v37
    v_mul_f32 v115, v115, v39
    v_mul_f32 v116, v116, v41
    v_mul_f32 v117, v117, v43
    v_mul_f32 v118, v118, v45
    v_mul_f32 v119, v119, v47
    v_mul_f32 v120, v120, v49
    v_mul_f32 v121, v121, v51
    v_mul_f32 v122, v122, v53
    v_mul_f32 v123, v123, v55
    v_mul_f32 v124, v124, v57
    v_mul_f32 v125, v125, v59
    v_mul_f32 v126, v126, v61
    v_mul_f32 v127, v127, v63
    v_cvt_pk_bf16_f32 v113, v112, v113
    v_lshlrev_b32 v112, 16, v113
    v_and_b32 v113, s71, v113
    v_cvt_pk_bf16_f32 v115, v114, v115
    v_lshlrev_b32 v114, 16, v115
    v_and_b32 v115, s71, v115
    v_cvt_pk_bf16_f32 v117, v116, v117
    v_lshlrev_b32 v116, 16, v117
    v_and_b32 v117, s71, v117
    v_cvt_pk_bf16_f32 v119, v118, v119
    v_lshlrev_b32 v118, 16, v119
    v_and_b32 v119, s71, v119
    v_cvt_pk_bf16_f32 v121, v120, v121
    v_lshlrev_b32 v120, 16, v121
    v_and_b32 v121, s71, v121
    v_cvt_pk_bf16_f32 v123, v122, v123
    v_lshlrev_b32 v122, 16, v123
    v_and_b32 v123, s71, v123
    v_cvt_pk_bf16_f32 v125, v124, v125
    v_lshlrev_b32 v124, 16, v125
    v_and_b32 v125, s71, v125
    v_cvt_pk_bf16_f32 v127, v126, v127
    v_lshlrev_b32 v126, 16, v127
    v_and_b32 v127, s71, v127
    v_mul_f32 v112, v112, v5
    v_mul_f32 v113, v113, v5
    v_mul_f32 v114, v114, v5
    v_mul_f32 v115, v115, v5
    v_mul_f32 v116, v116, v5
    v_mul_f32 v117, v117, v5
    v_mul_f32 v118, v118, v5
    v_mul_f32 v119, v119, v5
    v_mul_f32 v120, v120, v5
    v_mul_f32 v121, v121, v5
    v_mul_f32 v122, v122, v5
    v_mul_f32 v123, v123, v5
    v_mul_f32 v124, v124, v5
    v_mul_f32 v125, v125, v5
    v_mul_f32 v126, v126, v5
    v_mul_f32 v127, v127, v5
    v_cvt_pk_bf16_f32 v113, v112, v113
    v_lshlrev_b32 v112, 16, v113
    v_and_b32 v113, s71, v113
    v_cvt_pk_bf16_f32 v115, v114, v115
    v_lshlrev_b32 v114, 16, v115
    v_and_b32 v115, s71, v115
    v_cvt_pk_bf16_f32 v117, v116, v117
    v_lshlrev_b32 v116, 16, v117
    v_and_b32 v117, s71, v117
    v_cvt_pk_bf16_f32 v119, v118, v119
    v_lshlrev_b32 v118, 16, v119
    v_and_b32 v119, s71, v119
    v_cvt_pk_bf16_f32 v121, v120, v121
    v_lshlrev_b32 v120, 16, v121
    v_and_b32 v121, s71, v121
    v_cvt_pk_bf16_f32 v123, v122, v123
    v_lshlrev_b32 v122, 16, v123
    v_and_b32 v123, s71, v123
    v_cvt_pk_bf16_f32 v125, v124, v125
    v_lshlrev_b32 v124, 16, v125
    v_and_b32 v125, s71, v125
    v_cvt_pk_bf16_f32 v127, v126, v127
    v_lshlrev_b32 v126, 16, v127
    v_and_b32 v127, s71, v127
    s_mul_i32 s57, s40, 172032
    s_xor_b32 s11, s40, 1
    s_mul_i32 s56, s11, 172032
    s_lshr_b32 s11, s10, 1
    s_mul_i32 s11, s11, 86016
    s_add_u32 s11, s11, 57344
    s_add_u32 s56, s56, s11
    s_add_u32 s57, s57, s11
    s_and_b32 s12, s10, 1
    s_lshl_b32 s13, s12, 14
    s_add_u32 s52, s13, 0
    s_add_u32 s53, s13, 4096
    s_add_u32 s54, s13, 8192
    s_lshl_b32 s12, s12, 11
    s_add_u32 s55, s12, 12288
    s_mov_b32 s60, s42
    s_and_b32 s61, s43, 0xffff
    s_mov_b32 s62, 0x380000
    s_mov_b32 s63, 0x20000
    v_add_u32 v1, 0, v8
    v_add_u32 v2, 8192, v8
    v_mov_b32 v9, 162432
    s_xor_b32 s11, s10, 1
    s_mul_i32 s11, s11, 12288
    s_add_u32 s11, s11, 0
    v_add_u32 v3, s11, v6
    s_xor_b32 s11, s10, 3
    s_mul_i32 s11, s11, 12288
    s_add_u32 s11, s11, 4096
    v_add_u32 v12, s11, v6
    s_xor_b32 s11, s10, 2
    s_mul_i32 s11, s11, 12288
    s_add_u32 s11, s11, 8192
    v_add_u32 v13, s11, v6
    v_add_u32 v14, 106496, v8
    s_add_u32 s11, s16, 0
    buffer_load_dwordx4 v[144:147], v10, s[64:67], s11 offen sc1
    s_add_u32 s11, s16, 0
    buffer_load_dwordx4 v[148:151], v11, s[64:67], s11 offen sc1
    s_add_u32 s11, s16, 2048
    buffer_load_dwordx4 v[152:155], v10, s[64:67], s11 offen sc1
    s_add_u32 s11, s16, 2048
    buffer_load_dwordx4 v[156:159], v11, s[64:67], s11 offen sc1
    s_add_u32 s11, s16, 4096
    buffer_load_dwordx4 v[160:163], v10, s[64:67], s11 offen sc1
    s_add_u32 s11, s16, 4096
    buffer_load_dwordx4 v[164:167], v11, s[64:67], s11 offen sc1
    s_add_u32 s11, s16, 6144
    buffer_load_dwordx4 v[168:171], v10, s[64:67], s11 offen sc1
    s_add_u32 s11, s16, 6144
    buffer_load_dwordx4 v[172:175], v11, s[64:67], s11 offen sc1
    s_add_u32 s11, s16, 16384
    buffer_load_dwordx4 v[208:211], v10, s[64:67], s11 offen sc1
    s_add_u32 s11, s16, 16384
    buffer_load_dwordx4 v[212:215], v11, s[64:67], s11 offen sc1
    s_add_u32 s11, s16, 18432
    buffer_load_dwordx4 v[216:219], v10, s[64:67], s11 offen sc1
    s_add_u32 s11, s16, 18432
    buffer_load_dwordx4 v[220:223], v11, s[64:67], s11 offen sc1
    s_add_u32 s11, s16, 20480
    buffer_load_dwordx4 v[224:227], v10, s[64:67], s11 offen sc1
    s_add_u32 s11, s16, 20480
    buffer_load_dwordx4 v[228:231], v11, s[64:67], s11 offen sc1
    s_add_u32 s11, s16, 22528
    buffer_load_dwordx4 v[232:235], v10, s[64:67], s11 offen sc1
    s_add_u32 s11, s16, 22528
    buffer_load_dwordx4 v[236:239], v11, s[64:67], s11 offen sc1
    s_mov_b32 s73, 0
L_ps_spin_5:
    s_load_dwordx16 s[20:35], s[46:47], s18 glc
    s_waitcnt lgkmcnt(0)
    s_and_b64 s[20:21], s[20:21], s[22:23]
    s_and_b64 s[24:25], s[24:25], s[26:27]
    s_and_b64 s[28:29], s[28:29], s[30:31]
    s_and_b64 s[20:21], s[20:21], s[24:25]
    s_and_b64 s[28:29], s[28:29], s[32:33]
    s_and_b64 s[20:21], s[20:21], s[28:29]
    s_and_b32 s20, s20, s21
    s_cmp_eq_u32 s20, 1
    s_cbranch_scc1 L_ps_ok_6
    s_add_u32 s73, s73, 1
    s_cmp_lt_u32 s73, 1048576
    s_sleep 6
    s_cbranch_scc1 L_ps_spin_5
L_ps_ok_6:
    s_add_u32 s58, s56, s53
    buffer_load_dwordx4 v[16:19], v6, s[64:67], s58 offen offset:0 sc1
    buffer_load_dwordx4 v[20:23], v6, s[64:67], s58 offen offset:1024 sc1
    buffer_load_dwordx4 v[24:27], v6, s[64:67], s58 offen offset:2048 sc1
    buffer_load_dwordx4 v[28:31], v6, s[64:67], s58 offen offset:3072 sc1
    s_add_u32 s58, s56, s55
    buffer_load_dwordx4 v[32:35], v6, s[64:67], s58 offen offset:0 sc1
    buffer_load_dwordx4 v[36:39], v6, s[64:67], s58 offen offset:1024 sc1
    s_setprio 0
    s_waitcnt vmcnt(5)
    v_mfma_f32_32x32x16_bf16 v[96:111], v[16:19], v[180:183], 0
    v_mfma_f32_32x32x16_bf16 v[80:95], v[16:19], v[176:179], 0
    s_add_u32 s58, s56, s52
    buffer_load_dwordx4 v[40:43], v6, s[64:67], s58 offen offset:0 sc1
    buffer_load_dwordx4 v[44:47], v6, s[64:67], s58 offen offset:1024 sc1
    buffer_load_dwordx4 v[48:51], v6, s[64:67], s58 offen offset:2048 sc1
    s_waitcnt vmcnt(7)
    v_mfma_f32_32x32x16_bf16 v[96:111], v[20:23], v[188:191], v[96:111]
    v_mfma_f32_32x32x16_bf16 v[80:95], v[20:23], v[184:187], v[80:95]
    buffer_load_dwordx4 v[52:55], v6, s[64:67], s58 offen offset:3072 sc1
    s_add_u32 s58, s56, s54
    buffer_load_dwordx4 v[56:59], v6, s[64:67], s58 offen offset:0 sc1
    buffer_load_dwordx4 v[60:63], v6, s[64:67], s58 offen offset:1024 sc1
    s_waitcnt vmcnt(9)
    v_mfma_f32_32x32x16_bf16 v[96:111], v[24:27], v[196:199], v[96:111]
    v_mfma_f32_32x32x16_bf16 v[80:95], v[24:27], v[192:195], v[80:95]
    buffer_load_dwordx4 v[16:19], v6, s[64:67], s58 offen offset:2048 sc1
    buffer_load_dwordx4 v[20:23], v6, s[64:67], s58 offen offset:3072 sc1
    s_add_u32 s58, s57, s53
    buffer_load_dwordx4 v[24:27], v6, s[64:67], s58 offen offset:0 sc1
    s_waitcnt vmcnt(11)
    v_mfma_f32_32x32x16_bf16 v[96:111], v[28:31], v[204:207], v[96:111]
    v_mfma_f32_32x32x16_bf16 v[80:95], v[28:31], v[200:203], v[80:95]
    buffer_load_dwordx4 v[28:31], v6, s[64:67], s58 offen offset:1024 sc1
    s_waitcnt vmcnt(11)
    v_mfma_f32_32x32x16_bf16 v[96:111], v[32:35], v[244:247], v[96:111]
    v_mfma_f32_32x32x16_bf16 v[80:95], v[32:35], v[240:243], v[80:95]
    buffer_load_dwordx4 v[32:35], v6, s[64:67], s58 offen offset:2048 sc1
    s_waitcnt vmcnt(11)
    v_mfma_f32_32x32x16_bf16 v[96:111], v[36:39], v[252:255], v[96:111]
    v_mfma_f32_32x32x16_bf16 v[80:95], v[36:39], v[248:251], v[80:95]
    buffer_load_dwordx4 v[36:39], v6, s[64:67], s58 offen offset:3072 sc1
    s_waitcnt vmcnt(11)
    v_mfma_f32_32x32x16_bf16 v[96:111], v[40:43], v[148:151], v[96:111]
    v_mfma_f32_32x32x16_bf16 v[80:95], v[40:43], v[144:147], v[80:95]
    s_add_u32 s58, s57, s55
    buffer_load_dwordx4 v[40:43], v6, s[64:67], s58 offen offset:0 sc1
    s_waitcnt vmcnt(11)
    v_mfma_f32_32x32x16_bf16 v[96:111], v[44:47], v[156:159], v[96:111]
    v_mfma_f32_32x32x16_bf16 v[80:95], v[44:47], v[152:155], v[80:95]
    buffer_load_dwordx4 v[44:47], v6, s[64:67], s58 offen offset:1024 sc1
    s_waitcnt vmcnt(11)
    v_mfma_f32_32x32x16_bf16 v[96:111], v[48:51], v[164:167], v[96:111]
    v_mfma_f32_32x32x16_bf16 v[80:95], v[48:51], v[160:163], v[80:95]
    s_add_u32 s58, s57, s52
    buffer_load_dwordx4 v[48:51], v6, s[64:67], s58 offen offset:0 sc1
    s_waitcnt vmcnt(11)
    v_mfma_f32_32x32x16_bf16 v[96:111], v[52:55], v[172:175], v[96:111]
    v_mfma_f32_32x32x16_bf16 v[80:95], v[52:55], v[168:171], v[80:95]
    buffer_load_dwordx4 v[52:55], v6, s[64:67], s58 offen offset:1024 sc1
    s_waitcnt vmcnt(11)
    v_mfma_f32_32x32x16_bf16 v[96:111], v[56:59], v[212:215], v[96:111]
    v_mfma_f32_32x32x16_bf16 v[80:95], v[56:59], v[208:211], v[80:95]
    buffer_load_dwordx4 v[56:59], v6, s[64:67], s58 offen offset:2048 sc1
    s_waitcnt vmcnt(11)
    v_mfma_f32_32x32x16_bf16 v[96:111], v[60:63], v[220:223], v[96:111]
    v_mfma_f32_32x32x16_bf16 v[80:95], v[60:63], v[216:219], v[80:95]
    buffer_load_dwordx4 v[60:63], v6, s[64:67], s58 offen offset:3072 sc1
    s_waitcnt vmcnt(11)
    v_mfma_f32_32x32x16_bf16 v[96:111], v[16:19], v[228:231], v[96:111]
    v_mfma_f32_32x32x16_bf16 v[80:95], v[16:19], v[224:227], v[80:95]
    s_add_u32 s58, s57, s54
    buffer_load_dwordx4 v[16:19], v6, s[64:67], s58 offen offset:0 sc1
    s_waitcnt vmcnt(11)
    v_mfma_f32_32x32x16_bf16 v[96:111], v[20:23], v[236:239], v[96:111]
    v_mfma_f32_32x32x16_bf16 v[80:95], v[20:23], v[232:235], v[80:95]
    buffer_load_dwordx4 v[20:23], v6, s[64:67], s58 offen offset:1024 sc1
    s_waitcnt vmcnt(11)
    v_mfma_f32_32x32x16_bf16 v[128:143], v[24:27], v[180:183], 0
    v_mfma_f32_32x32x16_bf16 v[112:127], v[24:27], v[176:179], v[112:127]
    buffer_load_dwordx4 v[24:27], v6, s[64:67], s58 offen offset:2048 sc1
    ds_read_b32 v4, v9 offset:4
    s_waitcnt vmcnt(11)
    v_mfma_f32_32x32x16_bf16 v[128:143], v[28:31], v[188:191], v[128:143]
    v_mfma_f32_32x32x16_bf16 v[112:127], v[28:31], v[184:187], v[112:127]
    buffer_load_dwordx4 v[28:31], v6, s[64:67], s58 offen offset:3072 sc1
    s_mov_b32 s73, 0
L_l_c0:
    s_waitcnt lgkmcnt(0)
    v_readfirstlane_b32 s11, v4
    s_nop 0
    s_cmp_ge_u32 s11, 4
    s_cbranch_scc1 L_l_c0ok
    s_add_u32 s73, s73, 1
    s_cmp_ge_u32 s73, 1048576
    s_cbranch_scc1 L_l_c0ok
    s_sleep 1
    ds_read_b32 v4, v9 offset:4
    s_branch L_l_c0
L_l_c0ok:
    s_nop 7
    s_waitcnt vmcnt(11)
    v_mfma_f32_32x32x16_bf16 v[128:143], v[32:35], v[196:199], v[128:143]
    ds_write_b128 v1, v[80:83] offset:0
    s_waitcnt vmcnt(10)
    v_mfma_f32_32x32x16_bf16 v[128:143], v[36:39], v[204:207], v[128:143]
    ds_write_b128 v1, v[84:87] offset:1024
    s_waitcnt vmcnt(9)
    v_mfma_f32_32x32x16_bf16 v[128:143], v[40:43], v[244:247], v[128:143]
    ds_write_b128 v1, v[88:91] offset:2048
    s_waitcnt vmcnt(8)
    v_mfma_f32_32x32x16_bf16 v[128:143], v[44:47], v[252:255], v[128:143]
    ds_write_b128 v1, v[92:95] offset:3072
    s_waitcnt vmcnt(7)
    v_mfma_f32_32x32x16_bf16 v[128:143], v[48:51], v[148:151], v[128:143]
    ds_write_b128 v1, v[96:99] offset:4096
    s_waitcnt vmcnt(6)
    v_mfma_f32_32x32x16_bf16 v[128:143], v[52:55], v[156:159], v[128:143]
    ds_write_b128 v1, v[100:103] offset:5120
    s_waitcnt vmcnt(5)
    v_mfma_f32_32x32x16_bf16 v[128:143], v[56:59], v[164:167], v[128:143]
    ds_write_b128 v1, v[104:107] offset:6144
    s_waitcnt vmcnt(4)
    v_mfma_f32_32x32x16_bf16 v[128:143], v[60:63], v[172:175], v[128:143]
    ds_write_b128 v1, v[108:111] offset:7168
    s_waitcnt vmcnt(3)
    v_mfma_f32_32x32x16_bf16 v[128:143], v[16:19], v[212:215], v[128:143]
    s_waitcnt vmcnt(2)
    v_mfma_f32_32x32x16_bf16 v[128:143], v[20:23], v[220:223], v[128:143]
    s_waitcnt vmcnt(1)
    v_mfma_f32_32x32x16_bf16 v[128:143], v[24:27], v[228:231], v[128:143]
    s_waitcnt vmcnt(0)
    v_mfma_f32_32x32x16_bf16 v[128:143], v[28:31], v[236:239], v[128:143]
    v_mfma_f32_32x32x16_bf16 v[112:127], v[32:35], v[192:195], v[112:127]
    v_mfma_f32_32x32x16_bf16 v[112:127], v[36:39], v[200:203], v[112:127]
    s_nop 9
    ds_write_b128 v2, v[128:131] offset:0
    v_mfma_f32_32x32x16_bf16 v[112:127], v[40:43], v[240:243], v[112:127]
    ds_write_b128 v2, v[132:135] offset:1024
    v_mfma_f32_32x32x16_bf16 v[112:127], v[44:47], v[248:251], v[112:127]
    ds_write_b128 v2, v[136:139] offset:2048
    v_mfma_f32_32x32x16_bf16 v[112:127], v[48:51], v[144:147], v[112:127]
    ds_write_b128 v2, v[140:143] offset:3072
    v_mfma_f32_32x32x16_bf16 v[112:127], v[52:55], v[152:155], v[112:127]
    v_mfma_f32_32x32x16_bf16 v[112:127], v[56:59], v[160:163], v[112:127]
    s_waitcnt lgkmcnt(0)
    s_barrier
    ds_read_b128 v[80:83], v3 offset:0
    ds_read_b128 v[96:99], v12 offset:0
    ds_read_b128 v[128:131], v13 offset:0
    ds_read_b128 v[148:151], v14 offset:0
    v_mfma_f32_32x32x16_bf16 v[112:127], v[60:63], v[168:171], v[112:127]
    ds_read_b128 v[84:87], v3 offset:1024
    ds_read_b128 v[100:103], v12 offset:1024
    ds_read_b128 v[132:135], v13 offset:1024
    ds_read_b128 v[156:159], v14 offset:1024
    v_mfma_f32_32x32x16_bf16 v[112:127], v[16:19], v[208:211], v[112:127]
    ds_read_b128 v[88:91], v3 offset:2048
    ds_read_b128 v[104:107], v12 offset:2048
    ds_read_b128 v[136:139], v13 offset:2048
    ds_read_b128 v[164:167], v14 offset:2048
    v_mfma_f32_32x32x16_bf16 v[112:127], v[20:23], v[216:219], v[112:127]
    ds_read_b128 v[92:95], v3 offset:3072
    ds_read_b128 v[108:111], v12 offset:3072
    ds_read_b128 v[140:143], v13 offset:3072
    ds_read_b128 v[172:175], v14 offset:3072
    v_mfma_f32_32x32x16_bf16 v[112:127], v[24:27], v[224:227], v[112:127]
    s_waitcnt lgkmcnt(12)
    v_add_f32 v80, v80, v96
    v_add_f32 v81, v81, v97
    v_add_f32 v82, v82, v98
    v_add_f32 v83, v83, v99
    v_mfma_f32_32x32x16_bf16 v[112:127], v[28:31], v[232:235], v[112:127]
    v_add_f32 v80, v80, v128
    v_add_f32 v81, v81, v129
    v_add_f32 v82, v82, v130
    v_add_f32 v83, v83, v131
    v_fmac_f32 v64, v80, v148
    v_fmac_f32 v65, v81, v149
    v_fmac_f32 v66, v82, v150
    v_fmac_f32 v67, v83, v151
    s_waitcnt lgkmcnt(8)
    v_add_f32 v84, v84, v100
    v_add_f32 v85, v85, v101
    v_add_f32 v86, v86, v102
    v_add_f32 v87, v87, v103
    v_add_f32 v84, v84, v132
    v_add_f32 v85, v85, v133
    v_add_f32 v86, v86, v134
    v_add_f32 v87, v87, v135
    v_fmac_f32 v68, v84, v156
    v_fmac_f32 v69, v85, v157
    v_fmac_f32 v70, v86, v158
    v_fmac_f32 v71, v87, v159
    s_waitcnt lgkmcnt(4)
    v_add_f32 v88, v88, v104
    v_add_f32 v89, v89, v105
    v_add_f32 v90, v90, v106
    v_add_f32 v91, v91, v107
    v_add_f32 v88, v88, v136
    v_add_f32 v89, v89, v137
    v_add_f32 v90, v90, v138
    v_add_f32 v91, v91, v139
    v_fmac_f32 v72, v88, v164
    v_fmac_f32 v73, v89, v165
    v_fmac_f32 v74, v90, v166
    v_fmac_f32 v75, v91, v167
    s_waitcnt lgkmcnt(0)
    v_add_f32 v92, v92, v108
    v_add_f32 v93, v93, v109
    v_add_f32 v94, v94, v110
    v_add_f32 v95, v95, v111
    v_add_f32 v92, v92, v140
    v_add_f32 v93, v93, v141
    v_add_f32 v94, v94, v142
    v_add_f32 v95, v95, v143
    v_fmac_f32 v76, v92, v172
    v_fmac_f32 v77, v93, v173
    v_fmac_f32 v78, v94, v174
    v_fmac_f32 v79, v95, v175
    v_fmac_f32 v64, v112, v148
    s_mov_b32 s11, 0
    buffer_store_dword v64, v7, s[60:63], s11 offen offset:0 sc1
    v_fmac_f32 v65, v113, v149
    buffer_store_dword v65, v7, s[60:63], s11 offen offset:1792 sc1
    v_fmac_f32 v66, v114, v150
    s_mov_b32 s11, 3584
    buffer_store_dword v66, v7, s[60:63], s11 offen offset:0 sc1
    v_fmac_f32 v67, v115, v151
    buffer_store_dword v67, v7, s[60:63], s11 offen offset:1792 sc1
    v_fmac_f32 v68, v116, v156
    s_mov_b32 s11, 7168
    buffer_store_dword v68, v7, s[60:63], s11 offen offset:0 sc1
    v_fmac_f32 v69, v117, v157
    buffer_store_dword v69, v7, s[60:63], s11 offen offset:1792 sc1
    v_fmac_f32 v70, v118, v158
    s_mov_b32 s11, 10752
    buffer_store_dword v70, v7, s[60:63], s11 offen offset:0 sc1
    v_fmac_f32 v71, v119, v159
    buffer_store_dword v71, v7, s[60:63], s11 offen offset:1792 sc1
    v_fmac_f32 v72, v120, v164
    s_mov_b32 s11, 14336
    buffer_store_dword v72, v7, s[60:63], s11 offen offset:0 sc1
    v_fmac_f32 v73, v121, v165
    buffer_store_dword v73, v7, s[60:63], s11 offen offset:1792 sc1
    v_fmac_f32 v74, v122, v166
    s_mov_b32 s11, 17920
    buffer_store_dword v74, v7, s[60:63], s11 offen offset:0 sc1
    v_fmac_f32 v75, v123, v167
    buffer_store_dword v75, v7, s[60:63], s11 offen offset:1792 sc1
    v_fmac_f32 v76, v124, v172
    s_mov_b32 s11, 21504
    buffer_store_dword v76, v7, s[60:63], s11 offen offset:0 sc1
    v_fmac_f32 v77, v125, v173
    buffer_store_dword v77, v7, s[60:63], s11 offen offset:1792 sc1
    v_fmac_f32 v78, v126, v174
    s_mov_b32 s11, 25088
    buffer_store_dword v78, v7, s[60:63], s11 offen offset:0 sc1
    v_fmac_f32 v79, v127, v175
    buffer_store_dword v79, v7, s[60:63], s11 offen offset:1792 sc1
    s_endpgm
.p2align 12
L_consumer:
    v_and_b32 v24, 15, v0
    v_lshrrev_b32 v25, 5, v0
    v_lshrrev_b32 v29, 4, v0
    v_bfe_u32 v26, v0, 1, 3
    v_xor_b32 v26, v26, v29
    v_lshlrev_b32 v26, 4, v26
    v_lshl_add_u32 v26, v24, 7, v26
    s_lshl_b32 s11, s10, 13
    v_xor_b32 v27, 0, v26
    v_add_u32 v1, s11, v27
    v_add_u32 v3, 49152, v27
    v_xor_b32 v27, 64, v26
    v_add_u32 v2, s11, v27
    v_add_u32 v4, 49152, v27
    v_lshlrev_b32 v9, 4, v24
    v_lshl_add_u32 v9, v29, 9, v9
    v_bfe_u32 v26, v0, 2, 2
    v_lshlrev_b32 v27, 7, v26
    v_lshrrev_b32 v26, 1, v26
    v_lshl_add_u32 v27, v26, 6, v27
    v_bfe_u32 v26, v0, 4, 1
    v_lshl_add_u32 v27, v26, 5, v27
    v_and_b32 v28, 3, v0
    v_lshl_add_u32 v27, v28, 3, v27
    v_lshl_add_u32 v5, v29, 10, v27
    v_add_u32 v5, 32768, v5
    v_xor_b32 v6, 32, v5
    v_xor_b32 v7, 64, v5
    v_xor_b32 v8, 96, v5
    s_lshl_b32 s11, s10, 5
    v_xor_b32 v22, s11, v5
    s_and_b32 s11, s10, 1
    s_lshl_b32 s11, s11, 11
    v_add_u32 v20, s11, v3
    v_add_u32 v21, s11, v4
    s_mul_i32 s62, s10, 12288
    s_lshr_b32 s59, s10, 1
    s_and_b32 s63, s10, 1
    s_lshl_b32 s11, s59, 6
    v_lshl_add_u32 v19, v25, 9, v27
    v_xor_b32 v19, s11, v19
    v_add_u32 v19, s62, v19
    s_waitcnt lgkmcnt(0)
    s_lshl_b32 s11, s7, 5
    s_load_dwordx8 s[32:39], s[18:19], s11
    s_load_dwordx8 s[64:71], s[30:31], s11
    s_load_dwordx8 s[24:31], s[20:21], s11
    v_mov_b32 v96, 0
    v_mov_b32 v97, 0
    v_mov_b32 v98, 0
    v_mov_b32 v99, 0
    v_mov_b32 v17, 162432
    ds_write_b128 v17, v[96:99]
    ds_write_b128 v17, v[96:99] offset:16
    v_bfe_u32 v26, v0, 2, 1
    v_lshl_add_u32 v26, v26, 4, v28
    v_bfe_u32 v27, v0, 3, 1
    v_lshl_add_u32 v26, v27, 2, v26
    s_lshl_b32 s11, s10, 9
    s_add_u32 s11, s11, 159744
    v_lshl_add_u32 v12, v26, 3, s11
    v_lshlrev_b32 v11, 4, v0
    v_add_u32 v15, s62, v11
    v_lshlrev_b32 v13, 4, v29
    v_add_u32 v13, 161792, v13
    v_mov_b32 v10, 1
    s_lshl_b32 s11, s10, 2
    s_add_u32 s11, s11, 162448
    v_mov_b32 v18, s11
    s_lshl_b32 s11, s63, 8
    s_add_u32 s11, s11, 162464
    v_lshl_add_u32 v16, v25, 7, s11
    s_lshl_b32 s13, s6, 2
    s_add_u32 s13, s13, s10
    s_mul_i32 s56, s13, 344064
    s_cmp_ge_u32 s7, 14
    s_cselect_b32 s11, 28672, 0
    s_lshl_b32 s12, s7, 12
    s_add_u32 s11, s11, s12
    s_add_u32 s56, s56, s11
    s_add_u32 s57, s56, 172032
    s_lshl_b32 s11, s13, 10
    s_mul_i32 s14, s7, 37
    s_lshr_b32 s14, s14, 8
    s_mul_i32 s14, s14, 25
    s_add_u32 s12, s14, s7
    s_lshl_b32 s12, s12, 2
    s_add_u32 s11, s11, s12
    s_add_u32 s11, s11, 0xb0c000
    v_mov_b32 v14, s11
    s_lshl_b32 s55, s8, 10
    s_add_u32 s55, s55, 0xb0c000
    s_lshl_b32 s11, s10, 7
    s_add_u32 s55, s55, s11
    s_mul_i32 s12, s59, 86016
    s_mul_i32 s13, s63, 28672
    s_add_u32 s12, s12, s13
    s_lshl_b32 s11, s8, 1
    s_add_u32 s11, s11, s63
    s_mul_i32 s52, s11, 172032
    s_add_u32 s52, s52, s12
    s_xor_b32 s11, s11, 1
    s_mul_i32 s51, s11, 172032
    s_add_u32 s51, s51, s12
    s_lshl_b32 s11, s9, 2
    s_lshr_b32 s13, 0x0, s11
    s_and_b32 s13, s13, 15
    s_and_b32 s11, s5, 3
    s_lshl_b32 s11, s11, 1
    s_add_u32 s11, s11, s13
    s_cmp_ge_u32 s11, 7
    s_cselect_b32 s13, 7, 0
    s_sub_u32 s60, s11, s13
    s_mov_b32 s61, 0
    s_mov_b32 s58, 0
    s_mov_b32 s12, 0x00030003
    s_mov_b32 s13, 0x00030003
    s_waitcnt lgkmcnt(0)
    s_lshl_b64 exec, s[12:13], 0
    v_mov_b32 v40, s32
    v_mov_b32 v41, s24
    v_mov_b32 v42, s64
    s_lshl_b64 exec, s[12:13], 2
    v_mov_b32 v40, s33
    v_mov_b32 v41, s25
    v_mov_b32 v42, s65
    s_lshl_b64 exec, s[12:13], 4
    v_mov_b32 v40, s34
    v_mov_b32 v41, s26
    v_mov_b32 v42, s66
    s_lshl_b64 exec, s[12:13], 6
    v_mov_b32 v40, s35
    v_mov_b32 v41, s27
    v_mov_b32 v42, s67
    s_lshl_b64 exec, s[12:13], 8
    v_mov_b32 v40, s36
    v_mov_b32 v41, s28
    v_mov_b32 v42, s68
    s_lshl_b64 exec, s[12:13], 10
    v_mov_b32 v40, s37
    v_mov_b32 v41, s29
    v_mov_b32 v42, s69
    s_lshl_b64 exec, s[12:13], 12
    v_mov_b32 v40, s38
    v_mov_b32 v41, s30
    v_mov_b32 v42, s70
    s_lshl_b64 exec, s[12:13], 14
    v_mov_b32 v40, s39
    v_mov_b32 v41, s31
    v_mov_b32 v42, s71
    s_mov_b64 exec, -1
    v_and_b32 v43, 1, v0
    v_lshlrev_b32 v43, 4, v43
    v_lshrrev_b32 v40, v43, v40
    v_lshrrev_b32 v41, v43, v41
    v_lshrrev_b32 v42, v43, v42
    s_mov_b32 s64, s46
    s_and_b32 s65, s47, 0xffff
    s_mov_b32 s66, 0x1000000
    s_mov_b32 s67, 0x20000
    v_lshlrev_b32 v40, 16, v40
    v_lshlrev_b32 v41, 16, v41
    v_lshlrev_b32 v42, 16, v42
    s_mov_b32 s36, 0x3fb8aa3b
    s_mov_b32 s37, 0x32a57060
    v_mul_f32 v44, s36, v42
    v_fma_f32 v45, v42, s36, -v44
    v_fma_f32 v45, v42, s37, v45
    v_mul_f32 v45, 0x3f317218, v45
    v_exp_f32 v43, v44
    s_nop 0
    v_fma_f32 v43, v43, v45, v43
    v_cvt_pk_bf16_f32 v42, v43, v43
    v_lshlrev_b32 v42, 16, v42
    v_mul_f32 v43, v42, v40
    v_mul_f32 v46, v42, v41
    s_mov_b32 s36, 0x3fb8aa3b
    s_mov_b32 s37, 0x32a57060
    v_mul_f32 v44, s36, v43
    v_fma_f32 v45, v43, s36, -v44
    v_fma_f32 v45, v43, s37, v45
    v_mul_f32 v45, 0x3f317218, v45
    v_exp_f32 v47, v44
    s_nop 0
    v_fma_f32 v47, v47, v45, v47
    v_mul_f32 v46, 0x3e22f983, v46
    v_rndne_f32 v44, v46
    v_sub_f32 v46, v46, v44
    v_cos_f32 v44, v46
    v_sin_f32 v45, v46
    v_mul_f32 v64, v47, v44
    v_mul_f32 v65, v47, v45
    v_add_f32 v43, -1.0, v64
    v_mul_f32 v44, v40, v40
    v_fma_f32 v44, v41, v41, v44
    v_rcp_f32 v44, v44
    v_mul_f32 v66, v43, v40
    v_fma_f32 v66, v65, v41, v66
    v_mul_f32 v67, v65, v40
    v_fma_f32 v67, -v43, v41, v67
    v_add_f32 v44, v44, v44
    v_mul_f32 v66, v66, v44
    v_mul_f32 v67, v67, v44
    v_mul_f32 v40, v65, v65
    v_add_f32 v69, v65, v65
    v_mul_f32 v69, v69, v64
    v_fma_f32 v68, v64, v64, -v40
    v_mul_f32 v40, v69, v69
    v_add_f32 v69, v69, v69
    v_mul_f32 v69, v69, v68
    v_fma_f32 v68, v68, v68, -v40
    v_mul_f32 v40, v69, v69
    v_add_f32 v69, v69, v69
    v_mul_f32 v69, v69, v68
    v_fma_f32 v68, v68, v68, -v40
    v_mul_f32 v40, v69, v69
    v_add_f32 v69, v69, v69
    v_mul_f32 v69, v69, v68
    v_fma_f32 v68, v68, v68, -v40
    v_mov_b32 v70, v66
    v_mov_b32 v71, v67
    v_mul_f32 v41, v70, v68
    v_mul_f32 v42, v70, v69
    v_fma_f32 v41, -v71, v69, v41
    v_fma_f32 v42, v71, v68, v42
    v_and_b32 v40, 32, v0
    v_cmp_ne_u32 vcc, 0, v40
    s_nop 1
    v_cndmask_b32 v70, v70, v41, vcc
    v_cndmask_b32 v71, v71, v42, vcc
    v_mul_f32 v40, v69, v69
    v_add_f32 v55, v69, v69
    v_mul_f32 v55, v55, v68
    v_fma_f32 v54, v68, v68, -v40
    v_mul_f32 v41, v70, v54
    v_mul_f32 v42, v70, v55
    v_fma_f32 v41, -v71, v55, v41
    v_fma_f32 v42, v71, v54, v42
    v_and_b32 v40, 16, v0
    v_cmp_ne_u32 vcc, 0, v40
    s_nop 1
    v_cndmask_b32 v70, v70, v41, vcc
    v_cndmask_b32 v71, v71, v42, vcc
    v_mul_f32 v40, v55, v55
    v_add_f32 v73, v55, v55
    v_mul_f32 v73, v73, v54
    v_fma_f32 v72, v54, v54, -v40
    v_mov_b32 v50, s10
    v_mov_b32 v74, 1.0
    v_mov_b32 v75, 0
    v_mul_f32 v41, v74, v72
    v_mul_f32 v42, v74, v73
    v_fma_f32 v41, -v75, v73, v41
    v_fma_f32 v42, v75, v72, v42
    v_and_b32 v40, 1, v50
    v_cmp_ne_u32 vcc, 0, v40
    s_nop 1
    v_cndmask_b32 v74, v74, v41, vcc
    v_cndmask_b32 v75, v75, v42, vcc
    v_mul_f32 v40, v73, v73
    v_add_f32 v55, v73, v73
    v_mul_f32 v55, v55, v72
    v_fma_f32 v54, v72, v72, -v40
    v_mul_f32 v41, v74, v54
    v_mul_f32 v42, v74, v55
    v_fma_f32 v41, -v75, v55, v41
    v_fma_f32 v42, v75, v54, v42
    v_and_b32 v40, 2, v50
    v_cmp_ne_u32 vcc, 0, v40
    s_nop 1
    v_cndmask_b32 v74, v74, v41, vcc
    v_cndmask_b32 v75, v75, v42, vcc
    v_mul_f32 v40, v55, v55
    v_add_f32 v55, v55, v55
    v_mul_f32 v55, v55, v54
    v_fma_f32 v54, v54, v54, -v40
    v_lshrrev_b32 v50, 4, v0
    v_sub_u32 v50, s6, v50
    v_add_u32 v51, -5, v50
    v_add_u32 v50, -1, v50
    v_mov_b32 v76, 1.0
    v_mov_b32 v77, 0
    v_mov_b32 v78, 1.0
    v_mov_b32 v79, 0
    v_mul_f32 v41, v76, v54
    v_mul_f32 v42, v76, v55
    v_fma_f32 v41, -v77, v55, v41
    v_fma_f32 v42, v77, v54, v42
    v_and_b32 v40, 1, v50
    v_cmp_ne_u32 vcc, 0, v40
    s_nop 1
    v_cndmask_b32 v76, v76, v41, vcc
    v_cndmask_b32 v77, v77, v42, vcc
    v_mul_f32 v41, v78, v54
    v_mul_f32 v42, v78, v55
    v_fma_f32 v41, -v79, v55, v41
    v_fma_f32 v42, v79, v54, v42
    v_and_b32 v40, 1, v51
    v_cmp_ne_u32 vcc, 0, v40
    s_nop 1
    v_cndmask_b32 v78, v78, v41, vcc
    v_cndmask_b32 v79, v79, v42, vcc
    v_mul_f32 v40, v55, v55
    v_add_f32 v55, v55, v55
    v_mul_f32 v55, v55, v54
    v_fma_f32 v54, v54, v54, -v40
    v_mul_f32 v41, v76, v54
    v_mul_f32 v42, v76, v55
    v_fma_f32 v41, -v77, v55, v41
    v_fma_f32 v42, v77, v54, v42
    v_and_b32 v40, 2, v50
    v_cmp_ne_u32 vcc, 0, v40
    s_nop 1
    v_cndmask_b32 v76, v76, v41, vcc
    v_cndmask_b32 v77, v77, v42, vcc
    v_mul_f32 v41, v78, v54
    v_mul_f32 v42, v78, v55
    v_fma_f32 v41, -v79, v55, v41
    v_fma_f32 v42, v79, v54, v42
    v_and_b32 v40, 2, v51
    v_cmp_ne_u32 vcc, 0, v40
    s_nop 1
    v_cndmask_b32 v78, v78, v41, vcc
    v_cndmask_b32 v79, v79, v42, vcc
    v_mul_f32 v40, v55, v55
    v_add_f32 v55, v55, v55
    v_mul_f32 v55, v55, v54
    v_fma_f32 v54, v54, v54, -v40
    v_mul_f32 v41, v76, v54
    v_mul_f32 v42, v76, v55
    v_fma_f32 v41, -v77, v55, v41
    v_fma_f32 v42, v77, v54, v42
    v_and_b32 v40, 4, v50
    v_cmp_ne_u32 vcc, 0, v40
    s_nop 1
    v_cndmask_b32 v76, v76, v41, vcc
    v_cndmask_b32 v77, v77, v42, vcc
    s_add_u32 s36, s62, 8192
    v_bfe_u32 v40, v0, 4, 1
    v_lshrrev_b32 v41, 5, v0
    v_lshl_add_u32 v42, v40, 1, v41
    v_and_b32 v43, 15, v0
    v_and_b32 v80, 6, v43
    v_lshlrev_b32 v80, 4, v80
    v_lshlrev_b32 v44, 5, v42
    v_xor_b32 v80, v80, v44
    v_lshl_add_u32 v80, v43, 7, v80
    v_add_u32 v80, s36, v80
    v_lshlrev_b32 v82, 2, v43
    v_add_u32 v82, 162304, v82
    v_bfe_u32 v44, v0, 2, 2
    v_lshl_add_u32 v45, v41, 3, v44
    v_lshlrev_b32 v81, 7, v45
    v_lshrrev_b32 v44, 1, v44
    v_xor_b32 v44, v44, v0
    v_and_b32 v44, 1, v44
    v_lshl_add_u32 v81, v44, 5, v81
    v_lshl_add_u32 v81, v40, 4, v81
    v_bfe_u32 v44, v0, 1, 1
    v_lshl_add_u32 v81, v44, 3, v81
    v_add_u32 v81, s36, v81
    s_lshl_b32 s36, s10, 9
    s_add_u32 s36, s36, 159744
    v_lshl_add_u32 v83, v42, 7, s36
    v_lshlrev_b32 v84, 3, v43
    v_lshrrev_b32 v85, 4, v0
    v_mul_u32_u24 v85, 3584, v85
    s_lshl_b32 s36, s7, 7
    v_add3_u32 v85, v85, v84, s36
    v_add_u32 v84, 162976, v84
    s_lshl_b32 s36, s6, 2
    s_add_u32 s36, s36, s10
    s_lshl_b32 s36, s36, 10
    s_mul_i32 s38, s7, 37
    s_lshr_b32 s38, s38, 9
    s_mul_i32 s38, s38, 18
    s_add_u32 s37, s38, s7
    s_lshl_b32 s37, s37, 2
    s_add_u32 s36, s36, s37
    s_add_u32 s36, s36, 0xb0c200
    v_mov_b32 v86, s36
    v_mov_b32 v87, 0
    s_lshl_b32 s11, s10, 13
    s_add_u32 s11, s11, 106496
    v_add_u32 v40, s11, v11
    ds_write_b128 v40, v[64:67] offset:0
    ds_write_b128 v40, v[68:71] offset:1024
    ds_write_b128 v40, v[72:75] offset:2048
    ds_write_b128 v40, v[76:79] offset:3072
    ds_write_b128 v40, v[80:83] offset:4096
    ds_write_b128 v40, v[84:87] offset:5120
    s_waitcnt lgkmcnt(0)
    v_mov_b32 v80, 0x3f803f80
    v_mov_b32 v81, 0x3f803f80
    v_mov_b32 v82, 0x3f803f80
    v_mov_b32 v83, 0x3f803f80
    s_setprio 2
    s_mov_b32 s72, 0
    s_mov_b32 s74, 0
    s_barrier
    ds_read_b128 v[24:27], v1 offset:0
    ds_read_b128 v[28:31], v1 offset:2048
    ds_read_b128 v[32:35], v1 offset:4096
    ds_read_b128 v[36:39], v1 offset:6144
    ds_read_b128 v[56:59], v3 offset:0
    ds_read_b64_tr_b16 v[76:77], v22 offset:0
    ds_read_b64_tr_b16 v[78:79], v22 offset:512
    ds_read_b128 v[60:63], v3 offset:2048
    ds_read_b64_tr_b16 v[64:65], v5 offset:0
    ds_read_b64_tr_b16 v[66:67], v5 offset:512
    ds_read_b64_tr_b16 v[68:69], v5 offset:8192
    ds_read_b64_tr_b16 v[70:71], v5 offset:8704
    ds_read_b64_tr_b16 v[72:73], v6 offset:0
    ds_read_b64_tr_b16 v[74:75], v6 offset:512
    s_waitcnt lgkmcnt(10)
    s_waitcnt lgkmcnt(9)
    v_mfma_f32_16x16x32_bf16 v[224:227], v[24:27], v[56:59], 0
    v_mfma_f32_16x16x32_bf16 v[228:231], v[28:31], v[56:59], 0
    v_mfma_f32_16x16x32_bf16 v[232:235], v[32:35], v[56:59], 0
    v_mfma_f32_16x16x32_bf16 v[236:239], v[36:39], v[56:59], 0
    ds_read_b64_tr_b16 v[56:57], v6 offset:8192
    s_waitcnt lgkmcnt(7)
    v_mfma_f32_16x16x32_bf16 v[252:255], v[36:39], v[60:63], 0
    ds_read_b64_tr_b16 v[58:59], v6 offset:8704
    v_mfma_f32_16x16x32_bf16 v[248:251], v[32:35], v[60:63], 0
    v_mfma_f32_16x16x32_bf16 v[244:247], v[28:31], v[60:63], 0
    v_mfma_f32_16x16x32_bf16 v[240:243], v[24:27], v[60:63], 0
    ds_read_b64_tr_b16 v[60:61], v7 offset:0
    v_mfma_f32_16x16x32_bf16 v[84:87], v[76:79], v[80:83], 0
    s_waitcnt lgkmcnt(7)
    v_mfma_f32_16x16x32_bf16 v[96:99], v[64:67], v[24:27], 0
    ds_read_b64_tr_b16 v[76:77], v22 offset:8192
    v_mfma_f32_16x16x32_bf16 v[104:107], v[64:67], v[28:31], 0
    ds_read_b64_tr_b16 v[78:79], v22 offset:8704
    v_mfma_f32_16x16x32_bf16 v[112:115], v[64:67], v[32:35], 0
    ds_read_b64_tr_b16 v[62:63], v7 offset:512
    v_mfma_f32_16x16x32_bf16 v[120:123], v[64:67], v[36:39], 0
    ds_read_b64_tr_b16 v[64:65], v7 offset:8192
    s_waitcnt lgkmcnt(9)
    v_mfma_f32_16x16x32_bf16 v[184:187], v[68:71], v[36:39], 0
    ds_read_b64_tr_b16 v[66:67], v7 offset:8704
    v_mfma_f32_16x16x32_bf16 v[176:179], v[68:71], v[32:35], 0
    v_mfma_f32_16x16x32_bf16 v[168:171], v[68:71], v[28:31], 0
    v_mfma_f32_16x16x32_bf16 v[160:163], v[68:71], v[24:27], 0
    ds_read_b64_tr_b16 v[68:69], v8 offset:0
    s_waitcnt lgkmcnt(4)
    v_mfma_f32_16x16x32_bf16 v[88:91], v[76:79], v[80:83], 0
    v_mfma_f32_16x16x32_bf16 v[100:103], v[72:75], v[24:27], 0
    ds_read_b128 v[76:79], v20
    v_mfma_f32_16x16x32_bf16 v[108:111], v[72:75], v[28:31], 0
    ds_read_b64_tr_b16 v[70:71], v8 offset:512
    v_mfma_f32_16x16x32_bf16 v[116:119], v[72:75], v[32:35], 0
    v_mfma_f32_16x16x32_bf16 v[124:127], v[72:75], v[36:39], 0
    ds_read_b64_tr_b16 v[72:73], v8 offset:8192
    v_mfma_f32_16x16x32_bf16 v[188:191], v[56:59], v[36:39], 0
    ds_read_b64_tr_b16 v[74:75], v8 offset:8704
    v_mfma_f32_16x16x32_bf16 v[180:183], v[56:59], v[32:35], 0
    v_mfma_f32_16x16x32_bf16 v[172:175], v[56:59], v[28:31], 0
    v_mfma_f32_16x16x32_bf16 v[164:167], v[56:59], v[24:27], 0
    ds_read_b128 v[56:59], v4 offset:0
    s_waitcnt lgkmcnt(4)
    v_mfma_f32_16x16x32_bf16 v[92:95], v[80:83], v[76:79], 0
    v_mfma_f32_16x16x32_bf16 v[128:131], v[60:63], v[24:27], 0
    ds_read_b128 v[40:43], v2 offset:0
    v_mfma_f32_16x16x32_bf16 v[136:139], v[60:63], v[28:31], 0
    ds_read_b128 v[44:47], v2 offset:2048
    v_mfma_f32_16x16x32_bf16 v[144:147], v[60:63], v[32:35], 0
    ds_read_b128 v[48:51], v2 offset:4096
    v_mfma_f32_16x16x32_bf16 v[152:155], v[60:63], v[36:39], 0
    ds_read_b128 v[52:55], v2 offset:6144
    v_mfma_f32_16x16x32_bf16 v[216:219], v[64:67], v[36:39], 0
    ds_read_b128 v[60:63], v4 offset:2048
    v_mfma_f32_16x16x32_bf16 v[208:211], v[64:67], v[32:35], 0
    v_mfma_f32_16x16x32_bf16 v[200:203], v[64:67], v[28:31], 0
    v_mfma_f32_16x16x32_bf16 v[192:195], v[64:67], v[24:27], 0
    ds_read_b64_tr_b16 v[64:65], v5 offset:4096
    s_waitcnt lgkmcnt(9)
    v_mfma_f32_16x16x32_bf16 v[132:135], v[68:71], v[24:27], 0
    ds_read_b64_tr_b16 v[66:67], v5 offset:4608
    v_mfma_f32_16x16x32_bf16 v[140:143], v[68:71], v[28:31], 0
    v_mfma_f32_16x16x32_bf16 v[148:151], v[68:71], v[32:35], 0
    v_mfma_f32_16x16x32_bf16 v[156:159], v[68:71], v[36:39], 0
    ds_read_b64_tr_b16 v[68:69], v5 offset:12288
    s_waitcnt lgkmcnt(9)
    v_mfma_f32_16x16x32_bf16 v[220:223], v[72:75], v[36:39], 0
    ds_read_b64_tr_b16 v[70:71], v5 offset:12800
    v_mfma_f32_16x16x32_bf16 v[212:215], v[72:75], v[32:35], 0
    ds_read_b64_tr_b16 v[76:77], v22 offset:4096
    v_mfma_f32_16x16x32_bf16 v[204:207], v[72:75], v[28:31], 0
    ds_read_b64_tr_b16 v[78:79], v22 offset:4608
    v_mfma_f32_16x16x32_bf16 v[196:199], v[72:75], v[24:27], 0
    ds_read_b64_tr_b16 v[72:73], v6 offset:4096
    ds_read_b64_tr_b16 v[74:75], v6 offset:4608
    s_branch L_c_k1
L_c_loop:
    s_waitcnt lgkmcnt(10)
    s_waitcnt lgkmcnt(9)
    v_mfma_f32_16x16x32_bf16 v[224:227], v[24:27], v[56:59], v[224:227]
    v_mfma_f32_16x16x32_bf16 v[228:231], v[28:31], v[56:59], v[228:231]
    v_mfma_f32_16x16x32_bf16 v[232:235], v[32:35], v[56:59], v[232:235]
    v_mfma_f32_16x16x32_bf16 v[236:239], v[36:39], v[56:59], v[236:239]
    ds_read_b64_tr_b16 v[56:57], v6 offset:8192
    s_waitcnt lgkmcnt(7)
    v_mfma_f32_16x16x32_bf16 v[252:255], v[36:39], v[60:63], v[252:255]
    ds_read_b64_tr_b16 v[58:59], v6 offset:8704
    v_mfma_f32_16x16x32_bf16 v[248:251], v[32:35], v[60:63], v[248:251]
    v_mfma_f32_16x16x32_bf16 v[244:247], v[28:31], v[60:63], v[244:247]
    v_mfma_f32_16x16x32_bf16 v[240:243], v[24:27], v[60:63], v[240:243]
    ds_read_b64_tr_b16 v[60:61], v7 offset:0
    v_mfma_f32_16x16x32_bf16 v[84:87], v[76:79], v[80:83], v[84:87]
    s_waitcnt lgkmcnt(7)
    v_mfma_f32_16x16x32_bf16 v[96:99], v[64:67], v[24:27], v[96:99]
    ds_read_b64_tr_b16 v[76:77], v22 offset:8192
    v_mfma_f32_16x16x32_bf16 v[104:107], v[64:67], v[28:31], v[104:107]
    ds_read_b64_tr_b16 v[78:79], v22 offset:8704
    v_mfma_f32_16x16x32_bf16 v[112:115], v[64:67], v[32:35], v[112:115]
    ds_read_b64_tr_b16 v[62:63], v7 offset:512
    v_mfma_f32_16x16x32_bf16 v[120:123], v[64:67], v[36:39], v[120:123]
    ds_read_b64_tr_b16 v[64:65], v7 offset:8192
    s_waitcnt lgkmcnt(9)
    v_mfma_f32_16x16x32_bf16 v[184:187], v[68:71], v[36:39], v[184:187]
    ds_read_b64_tr_b16 v[66:67], v7 offset:8704
    v_mfma_f32_16x16x32_bf16 v[176:179], v[68:71], v[32:35], v[176:179]
    v_mfma_f32_16x16x32_bf16 v[168:171], v[68:71], v[28:31], v[168:171]
    v_mfma_f32_16x16x32_bf16 v[160:163], v[68:71], v[24:27], v[160:163]
    ds_read_b64_tr_b16 v[68:69], v8 offset:0
    s_waitcnt lgkmcnt(4)
    v_mfma_f32_16x16x32_bf16 v[88:91], v[76:79], v[80:83], v[88:91]
    v_mfma_f32_16x16x32_bf16 v[100:103], v[72:75], v[24:27], v[100:103]
    ds_read_b128 v[76:79], v20
    v_mfma_f32_16x16x32_bf16 v[108:111], v[72:75], v[28:31], v[108:111]
    ds_read_b64_tr_b16 v[70:71], v8 offset:512
    v_mfma_f32_16x16x32_bf16 v[116:119], v[72:75], v[32:35], v[116:119]
    v_mfma_f32_16x16x32_bf16 v[124:127], v[72:75], v[36:39], v[124:127]
    ds_read_b64_tr_b16 v[72:73], v8 offset:8192
    v_mfma_f32_16x16x32_bf16 v[188:191], v[56:59], v[36:39], v[188:191]
    ds_read_b64_tr_b16 v[74:75], v8 offset:8704
    v_mfma_f32_16x16x32_bf16 v[180:183], v[56:59], v[32:35], v[180:183]
    v_mfma_f32_16x16x32_bf16 v[172:175], v[56:59], v[28:31], v[172:175]
    v_mfma_f32_16x16x32_bf16 v[164:167], v[56:59], v[24:27], v[164:167]
    ds_read_b128 v[56:59], v4 offset:0
    s_waitcnt lgkmcnt(4)
    v_mfma_f32_16x16x32_bf16 v[92:95], v[80:83], v[76:79], v[92:95]
    v_mfma_f32_16x16x32_bf16 v[128:131], v[60:63], v[24:27], v[128:131]
    ds_read_b128 v[40:43], v2 offset:0
    v_mfma_f32_16x16x32_bf16 v[136:139], v[60:63], v[28:31], v[136:139]
    ds_read_b128 v[44:47], v2 offset:2048
    v_mfma_f32_16x16x32_bf16 v[144:147], v[60:63], v[32:35], v[144:147]
    ds_read_b128 v[48:51], v2 offset:4096
    v_mfma_f32_16x16x32_bf16 v[152:155], v[60:63], v[36:39], v[152:155]
    ds_read_b128 v[52:55], v2 offset:6144
    v_mfma_f32_16x16x32_bf16 v[216:219], v[64:67], v[36:39], v[216:219]
    ds_read_b128 v[60:63], v4 offset:2048
    v_mfma_f32_16x16x32_bf16 v[208:211], v[64:67], v[32:35], v[208:211]
    v_mfma_f32_16x16x32_bf16 v[200:203], v[64:67], v[28:31], v[200:203]
    v_mfma_f32_16x16x32_bf16 v[192:195], v[64:67], v[24:27], v[192:195]
    ds_read_b64_tr_b16 v[64:65], v5 offset:4096
    s_waitcnt lgkmcnt(9)
    v_mfma_f32_16x16x32_bf16 v[132:135], v[68:71], v[24:27], v[132:135]
    ds_read_b64_tr_b16 v[66:67], v5 offset:4608
    v_mfma_f32_16x16x32_bf16 v[140:143], v[68:71], v[28:31], v[140:143]
    v_mfma_f32_16x16x32_bf16 v[148:151], v[68:71], v[32:35], v[148:151]
    v_mfma_f32_16x16x32_bf16 v[156:159], v[68:71], v[36:39], v[156:159]
    ds_read_b64_tr_b16 v[68:69], v5 offset:12288
    s_waitcnt lgkmcnt(9)
    v_mfma_f32_16x16x32_bf16 v[220:223], v[72:75], v[36:39], v[220:223]
    ds_read_b64_tr_b16 v[70:71], v5 offset:12800
    v_mfma_f32_16x16x32_bf16 v[212:215], v[72:75], v[32:35], v[212:215]
    ds_read_b64_tr_b16 v[76:77], v22 offset:4096
    v_mfma_f32_16x16x32_bf16 v[204:207], v[72:75], v[28:31], v[204:207]
    ds_read_b64_tr_b16 v[78:79], v22 offset:4608
    v_mfma_f32_16x16x32_bf16 v[196:199], v[72:75], v[24:27], v[196:199]
    ds_read_b64_tr_b16 v[72:73], v6 offset:4096
    ds_read_b64_tr_b16 v[74:75], v6 offset:4608
L_c_k1:
    s_waitcnt lgkmcnt(9)
    v_mfma_f32_16x16x32_bf16 v[224:227], v[40:43], v[56:59], v[224:227]
    s_add_u32 s74, s74, 1
    v_mfma_f32_16x16x32_bf16 v[228:231], v[44:47], v[56:59], v[228:231]
    s_cmp_eq_u32 s74, 3
    v_mfma_f32_16x16x32_bf16 v[232:235], v[48:51], v[56:59], v[232:235]
    s_mov_b32 s75, 53248
    v_mfma_f32_16x16x32_bf16 v[236:239], v[52:55], v[56:59], v[236:239]
    ds_read_b64_tr_b16 v[56:57], v6 offset:12288
    s_cmov_b32 s75, 0xfffe6000
    s_waitcnt lgkmcnt(9)
    v_mfma_f32_16x16x32_bf16 v[252:255], v[52:55], v[60:63], v[252:255]
    ds_read_b64_tr_b16 v[58:59], v6 offset:12800
    s_cselect_b32 s74, 0, s74
    v_mfma_f32_16x16x32_bf16 v[248:251], v[48:51], v[60:63], v[248:251]
    s_add_u32 s72, s72, 1
    v_mfma_f32_16x16x32_bf16 v[244:247], v[44:47], v[60:63], v[244:247]
    s_cmp_eq_u32 s72, 6
    v_mfma_f32_16x16x32_bf16 v[240:243], v[40:43], v[60:63], v[240:243]
    ds_read_b64_tr_b16 v[60:61], v7 offset:4096
    v_add_u32 v1, s75, v1
    s_waitcnt lgkmcnt(5)
    v_mfma_f32_16x16x32_bf16 v[84:87], v[76:79], v[80:83], v[84:87]
    v_mfma_f32_16x16x32_bf16 v[96:99], v[64:67], v[40:43], v[96:99]
    ds_read_b64_tr_b16 v[76:77], v22 offset:12288
    v_add_u32 v2, s75, v2
    v_mfma_f32_16x16x32_bf16 v[104:107], v[64:67], v[44:47], v[104:107]
    ds_read_b64_tr_b16 v[78:79], v22 offset:12800
    v_add_u32 v3, s75, v3
    v_mfma_f32_16x16x32_bf16 v[112:115], v[64:67], v[48:51], v[112:115]
    ds_read_b64_tr_b16 v[62:63], v7 offset:4608
    v_add_u32 v4, s75, v4
    v_mfma_f32_16x16x32_bf16 v[120:123], v[64:67], v[52:55], v[120:123]
    ds_read_b64_tr_b16 v[64:65], v7 offset:12288
    v_add_u32 v20, s75, v20
    v_mfma_f32_16x16x32_bf16 v[184:187], v[68:71], v[52:55], v[184:187]
    ds_read_b64_tr_b16 v[66:67], v7 offset:12800
    v_add_u32 v5, s75, v5
    v_mfma_f32_16x16x32_bf16 v[176:179], v[68:71], v[48:51], v[176:179]
    v_mfma_f32_16x16x32_bf16 v[168:171], v[68:71], v[44:47], v[168:171]
    v_mfma_f32_16x16x32_bf16 v[160:163], v[68:71], v[40:43], v[160:163]
    ds_read_b64_tr_b16 v[68:69], v8 offset:4096
    s_waitcnt lgkmcnt(4)
    v_mfma_f32_16x16x32_bf16 v[88:91], v[76:79], v[80:83], v[88:91]
    v_mfma_f32_16x16x32_bf16 v[100:103], v[72:75], v[40:43], v[100:103]
    ds_read_b128 v[76:79], v21
    v_mfma_f32_16x16x32_bf16 v[108:111], v[72:75], v[44:47], v[108:111]
    ds_read_b64_tr_b16 v[70:71], v8 offset:4608
    v_mfma_f32_16x16x32_bf16 v[116:119], v[72:75], v[48:51], v[116:119]
    v_mfma_f32_16x16x32_bf16 v[124:127], v[72:75], v[52:55], v[124:127]
    ds_read_b64_tr_b16 v[72:73], v8 offset:12288
    ds_read_b64_tr_b16 v[74:75], v8 offset:12800
    v_mfma_f32_16x16x32_bf16 v[188:191], v[56:59], v[52:55], v[188:191]
    v_add_u32 v6, s75, v6
    v_mfma_f32_16x16x32_bf16 v[180:183], v[56:59], v[48:51], v[180:183]
    v_add_u32 v7, s75, v7
    v_mfma_f32_16x16x32_bf16 v[172:175], v[56:59], v[44:47], v[172:175]
    v_add_u32 v8, s75, v8
    v_mfma_f32_16x16x32_bf16 v[164:167], v[56:59], v[40:43], v[164:167]
    v_add_u32 v22, s75, v22
    s_waitcnt lgkmcnt(3)
    v_mfma_f32_16x16x32_bf16 v[92:95], v[80:83], v[76:79], v[92:95]
    v_add_u32 v21, s75, v21
    s_waitcnt lgkmcnt(0)
    s_barrier
    s_cbranch_scc1 L_c_last
    v_mfma_f32_16x16x32_bf16 v[128:131], v[60:63], v[40:43], v[128:131]
    ds_read_b128 v[24:27], v1 offset:0
    v_mfma_f32_16x16x32_bf16 v[136:139], v[60:63], v[44:47], v[136:139]
    ds_read_b128 v[28:31], v1 offset:2048
    v_mfma_f32_16x16x32_bf16 v[144:147], v[60:63], v[48:51], v[144:147]
    ds_read_b128 v[32:35], v1 offset:4096
    v_mfma_f32_16x16x32_bf16 v[152:155], v[60:63], v[52:55], v[152:155]
    ds_read_b128 v[36:39], v1 offset:6144
    v_mfma_f32_16x16x32_bf16 v[216:219], v[64:67], v[52:55], v[216:219]
    ds_read_b128 v[56:59], v3 offset:0
    v_mfma_f32_16x16x32_bf16 v[208:211], v[64:67], v[48:51], v[208:211]
    ds_read_b64_tr_b16 v[76:77], v22 offset:0
    v_mfma_f32_16x16x32_bf16 v[200:203], v[64:67], v[44:47], v[200:203]
    ds_read_b64_tr_b16 v[78:79], v22 offset:512
    v_mfma_f32_16x16x32_bf16 v[192:195], v[64:67], v[40:43], v[192:195]
    ds_read_b128 v[60:63], v3 offset:2048
    v_mfma_f32_16x16x32_bf16 v[132:135], v[68:71], v[40:43], v[132:135]
    ds_read_b64_tr_b16 v[64:65], v5 offset:0
    v_mfma_f32_16x16x32_bf16 v[140:143], v[68:71], v[44:47], v[140:143]
    ds_read_b64_tr_b16 v[66:67], v5 offset:512
    v_mfma_f32_16x16x32_bf16 v[148:151], v[68:71], v[48:51], v[148:151]
    v_mfma_f32_16x16x32_bf16 v[156:159], v[68:71], v[52:55], v[156:159]
    ds_read_b64_tr_b16 v[68:69], v5 offset:8192
    v_mfma_f32_16x16x32_bf16 v[220:223], v[72:75], v[52:55], v[220:223]
    ds_read_b64_tr_b16 v[70:71], v5 offset:8704
    v_mfma_f32_16x16x32_bf16 v[212:215], v[72:75], v[48:51], v[212:215]
    v_mfma_f32_16x16x32_bf16 v[204:207], v[72:75], v[44:47], v[204:207]
    v_mfma_f32_16x16x32_bf16 v[196:199], v[72:75], v[40:43], v[196:199]
    ds_read_b64_tr_b16 v[72:73], v6 offset:0
    ds_read_b64_tr_b16 v[74:75], v6 offset:512
    s_branch L_c_loop
L_c_last:
    v_mfma_f32_16x16x32_bf16 v[128:131], v[60:63], v[40:43], v[128:131]
    ds_read_b64_tr_b16 v[76:77], v22 offset:0
    v_mfma_f32_16x16x32_bf16 v[136:139], v[60:63], v[44:47], v[136:139]
    ds_read_b64_tr_b16 v[78:79], v22 offset:512
    v_mfma_f32_16x16x32_bf16 v[144:147], v[60:63], v[48:51], v[144:147]
    ds_read_b64_tr_b16 v[56:57], v22 offset:8192
    v_mfma_f32_16x16x32_bf16 v[152:155], v[60:63], v[52:55], v[152:155]
    ds_read_b64_tr_b16 v[58:59], v22 offset:8704
    v_mfma_f32_16x16x32_bf16 v[216:219], v[64:67], v[52:55], v[216:219]
    ds_read_b128 v[24:27], v1 offset:0
    v_mfma_f32_16x16x32_bf16 v[208:211], v[64:67], v[48:51], v[208:211]
    ds_read_b128 v[28:31], v1 offset:2048
    v_mfma_f32_16x16x32_bf16 v[200:203], v[64:67], v[44:47], v[200:203]
    ds_read_b128 v[32:35], v1 offset:4096
    v_mfma_f32_16x16x32_bf16 v[192:195], v[64:67], v[40:43], v[192:195]
    ds_read_b128 v[36:39], v1 offset:6144
    v_mfma_f32_16x16x32_bf16 v[132:135], v[68:71], v[40:43], v[132:135]
    ds_read_b128 v[60:63], v20
    v_mfma_f32_16x16x32_bf16 v[140:143], v[68:71], v[44:47], v[140:143]
    ds_read_b64_tr_b16 v[64:65], v22 offset:4096
    v_mfma_f32_16x16x32_bf16 v[148:151], v[68:71], v[48:51], v[148:151]
    ds_read_b64_tr_b16 v[66:67], v22 offset:4608
    v_mfma_f32_16x16x32_bf16 v[156:159], v[68:71], v[52:55], v[156:159]
    ds_read_b64_tr_b16 v[68:69], v22 offset:12288
    v_mfma_f32_16x16x32_bf16 v[220:223], v[72:75], v[52:55], v[220:223]
    ds_read_b64_tr_b16 v[70:71], v22 offset:12800
    v_mfma_f32_16x16x32_bf16 v[212:215], v[72:75], v[48:51], v[212:215]
    v_mfma_f32_16x16x32_bf16 v[204:207], v[72:75], v[44:47], v[204:207]
    v_mfma_f32_16x16x32_bf16 v[196:199], v[72:75], v[40:43], v[196:199]
    ds_read_b128 v[72:75], v21
    s_waitcnt lgkmcnt(12)
    v_mfma_f32_16x16x32_bf16 v[84:87], v[76:79], v[80:83], v[84:87]
    ds_read_b128 v[40:43], v2 offset:0
    ds_read_b128 v[44:47], v2 offset:2048
    s_waitcnt lgkmcnt(12)
    v_mfma_f32_16x16x32_bf16 v[88:91], v[56:59], v[80:83], v[88:91]
    ds_read_b128 v[48:51], v2 offset:4096
    ds_read_b128 v[52:55], v2 offset:6144
    s_waitcnt lgkmcnt(9)
    v_mfma_f32_16x16x32_bf16 v[92:95], v[80:83], v[60:63], v[92:95]
    ds_read_b64_tr_b16 v[76:77], v5 offset:0
    ds_read_b64_tr_b16 v[78:79], v5 offset:512
    s_waitcnt lgkmcnt(9)
    v_mfma_f32_16x16x32_bf16 v[84:87], v[64:67], v[80:83], v[84:87]
    ds_read_b64_tr_b16 v[56:57], v5 offset:8192
    ds_read_b64_tr_b16 v[58:59], v5 offset:8704
    s_waitcnt lgkmcnt(9)
    v_mfma_f32_16x16x32_bf16 v[88:91], v[68:71], v[80:83], v[88:91]
    ds_read_b64_tr_b16 v[60:61], v6 offset:0
    ds_read_b64_tr_b16 v[62:63], v6 offset:512
    s_waitcnt lgkmcnt(10)
    v_mfma_f32_16x16x32_bf16 v[92:95], v[80:83], v[72:75], v[92:95]
    ds_read_b64_tr_b16 v[64:65], v6 offset:8192
    ds_read_b64_tr_b16 v[66:67], v6 offset:8704
    s_waitcnt lgkmcnt(6)
    v_mfma_f32_16x16x32_bf16 v[96:99], v[76:79], v[24:27], v[96:99]
    ds_read_b64_tr_b16 v[68:69], v5 offset:4096
    ds_read_b64_tr_b16 v[70:71], v5 offset:4608
    v_mfma_f32_16x16x32_bf16 v[104:107], v[76:79], v[28:31], v[104:107]
    ds_read_b64_tr_b16 v[72:73], v5 offset:12288
    ds_read_b64_tr_b16 v[74:75], v5 offset:12800
    v_mfma_f32_16x16x32_bf16 v[112:115], v[76:79], v[32:35], v[112:115]
    v_mfma_f32_16x16x32_bf16 v[120:123], v[76:79], v[36:39], v[120:123]
    ds_read_b64_tr_b16 v[76:77], v6 offset:4096
    ds_read_b64_tr_b16 v[78:79], v6 offset:4608
    s_waitcnt lgkmcnt(10)
    v_mfma_f32_16x16x32_bf16 v[184:187], v[56:59], v[36:39], v[184:187]
    v_mfma_f32_16x16x32_bf16 v[176:179], v[56:59], v[32:35], v[176:179]
    v_mfma_f32_16x16x32_bf16 v[168:171], v[56:59], v[28:31], v[168:171]
    v_mfma_f32_16x16x32_bf16 v[160:163], v[56:59], v[24:27], v[160:163]
    ds_read_b64_tr_b16 v[56:57], v6 offset:12288
    ds_read_b64_tr_b16 v[58:59], v6 offset:12800
    s_lshl_b32 s11, s10, 6
    v_add_u32 v22, s11, v13
    v_subrev_u32 v20, v3, v20
    v_lshrrev_b32 v20, 5, v20
    v_and_b32 v21, 15, v0
    v_lshl_add_u32 v20, v21, 2, v20
    v_add_u32 v20, 162304, v20
    s_mov_b32 exec_lo, 0x00010001
    s_mov_b32 exec_hi, 0x00010001
    ds_write_b128 v22, v[84:87]
    ds_write_b128 v22, v[88:91] offset:256
    s_mov_b64 exec, 0xffff
    ds_write_b32 v20, v92
    s_mov_b64 exec, -1
    s_waitcnt lgkmcnt(12)
    v_mfma_f32_16x16x32_bf16 v[100:103], v[60:63], v[24:27], v[100:103]
    v_mfma_f32_16x16x32_bf16 v[108:111], v[60:63], v[28:31], v[108:111]
    v_mfma_f32_16x16x32_bf16 v[116:119], v[60:63], v[32:35], v[116:119]
    v_mfma_f32_16x16x32_bf16 v[124:127], v[60:63], v[36:39], v[124:127]
    ds_read_b64_tr_b16 v[60:61], v7 offset:0
    s_waitcnt lgkmcnt(12)
    v_mfma_f32_16x16x32_bf16 v[188:191], v[64:67], v[36:39], v[188:191]
    ds_read_b64_tr_b16 v[62:63], v7 offset:512
    v_mfma_f32_16x16x32_bf16 v[180:183], v[64:67], v[32:35], v[180:183]
    v_mfma_f32_16x16x32_bf16 v[172:175], v[64:67], v[28:31], v[172:175]
    v_mfma_f32_16x16x32_bf16 v[164:167], v[64:67], v[24:27], v[164:167]
    ds_read_b64_tr_b16 v[64:65], v7 offset:8192
    s_waitcnt lgkmcnt(12)
    v_mfma_f32_16x16x32_bf16 v[96:99], v[68:71], v[40:43], v[96:99]
    ds_read_b64_tr_b16 v[66:67], v7 offset:8704
    v_mfma_f32_16x16x32_bf16 v[104:107], v[68:71], v[44:47], v[104:107]
    v_mfma_f32_16x16x32_bf16 v[112:115], v[68:71], v[48:51], v[112:115]
    v_mfma_f32_16x16x32_bf16 v[120:123], v[68:71], v[52:55], v[120:123]
    ds_read_b64_tr_b16 v[68:69], v8 offset:0
    s_waitcnt lgkmcnt(5)
    s_barrier
    ds_read_b32 v20, v12 offset:0
    ds_read_b32 v21, v12 offset:64
    ds_read_b32 v22, v12 offset:256
    ds_read_b32 v23, v12 offset:320
    ds_read_b128 v[80:83], v13 offset:0
    ds_read_b128 v[84:87], v13 offset:64
    ds_read_b128 v[88:91], v13 offset:256
    ds_read_b128 v[92:95], v13 offset:320
    v_mfma_f32_16x16x32_bf16 v[184:187], v[72:75], v[52:55], v[184:187]
    ds_read_b64_tr_b16 v[70:71], v8 offset:512
    v_mfma_f32_16x16x32_bf16 v[176:179], v[72:75], v[48:51], v[176:179]
    v_mfma_f32_16x16x32_bf16 v[168:171], v[72:75], v[44:47], v[168:171]
    v_mfma_f32_16x16x32_bf16 v[160:163], v[72:75], v[40:43], v[160:163]
    ds_read_b64_tr_b16 v[72:73], v8 offset:8192
    v_mfma_f32_16x16x32_bf16 v[100:103], v[76:79], v[40:43], v[100:103]
    ds_read_b64_tr_b16 v[74:75], v8 offset:8704
    v_mfma_f32_16x16x32_bf16 v[108:111], v[76:79], v[44:47], v[108:111]
    v_mfma_f32_16x16x32_bf16 v[116:119], v[76:79], v[48:51], v[116:119]
    v_mfma_f32_16x16x32_bf16 v[124:127], v[76:79], v[52:55], v[124:127]
    ds_read_b64_tr_b16 v[76:77], v7 offset:4096
    v_mfma_f32_16x16x32_bf16 v[188:191], v[56:59], v[52:55], v[188:191]
    ds_read_b64_tr_b16 v[78:79], v7 offset:4608
    v_mfma_f32_16x16x32_bf16 v[180:183], v[56:59], v[48:51], v[180:183]
    v_mfma_f32_16x16x32_bf16 v[172:175], v[56:59], v[44:47], v[172:175]
    v_mfma_f32_16x16x32_bf16 v[164:167], v[56:59], v[40:43], v[164:167]
    ds_read_b64_tr_b16 v[56:57], v7 offset:12288
    s_waitcnt lgkmcnt(12)
    v_mfma_f32_16x16x32_bf16 v[128:131], v[60:63], v[24:27], v[128:131]
    ds_read_b64_tr_b16 v[58:59], v7 offset:12800
    v_mfma_f32_16x16x32_bf16 v[136:139], v[60:63], v[28:31], v[136:139]
    v_mfma_f32_16x16x32_bf16 v[144:147], v[60:63], v[32:35], v[144:147]
    s_waitcnt lgkmcnt(7)
    v_xor_b32 v20, 0x80000000, v20
    v_mfma_f32_16x16x32_bf16 v[152:155], v[60:63], v[36:39], v[152:155]
    ds_read_b64_tr_b16 v[60:61], v8 offset:4096
    v_xor_b32 v21, 0x80000000, v21
    v_mfma_f32_16x16x32_bf16 v[216:219], v[64:67], v[36:39], v[216:219]
    ds_read_b64_tr_b16 v[62:63], v8 offset:4608
    v_xor_b32 v22, 0x80000000, v22
    v_mfma_f32_16x16x32_bf16 v[208:211], v[64:67], v[32:35], v[208:211]
    v_xor_b32 v23, 0x80000000, v23
    v_fmac_f32 v96, v20, v80
    v_mfma_f32_16x16x32_bf16 v[200:203], v[64:67], v[28:31], v[200:203]
    v_fmac_f32 v97, v20, v81
    v_fmac_f32 v98, v20, v82
    v_mfma_f32_16x16x32_bf16 v[192:195], v[64:67], v[24:27], v[192:195]
    ds_read_b64_tr_b16 v[64:65], v8 offset:12288
    v_fmac_f32 v99, v20, v83
    s_waitcnt lgkmcnt(9)
    v_mfma_f32_16x16x32_bf16 v[132:135], v[68:71], v[24:27], v[132:135]
    ds_read_b64_tr_b16 v[66:67], v8 offset:12800
    v_fmac_f32 v100, v20, v84
    v_mfma_f32_16x16x32_bf16 v[140:143], v[68:71], v[28:31], v[140:143]
    v_fmac_f32 v101, v20, v85
    v_fmac_f32 v102, v20, v86
    v_mfma_f32_16x16x32_bf16 v[148:151], v[68:71], v[32:35], v[148:151]
    v_fmac_f32 v103, v20, v87
    v_fmac_f32 v160, v20, v88
    v_mfma_f32_16x16x32_bf16 v[156:159], v[68:71], v[36:39], v[156:159]
    ds_read_b128 v[68:71], v3 offset:0
    v_fmac_f32 v161, v20, v89
    s_waitcnt lgkmcnt(9)
    v_mfma_f32_16x16x32_bf16 v[220:223], v[72:75], v[36:39], v[220:223]
    v_fmac_f32 v162, v20, v90
    v_fmac_f32 v163, v20, v91
    v_mfma_f32_16x16x32_bf16 v[212:215], v[72:75], v[32:35], v[212:215]
    v_fmac_f32 v164, v20, v92
    v_fmac_f32 v165, v20, v93
    v_mfma_f32_16x16x32_bf16 v[204:207], v[72:75], v[28:31], v[204:207]
    v_fmac_f32 v166, v20, v94
    v_fmac_f32 v167, v20, v95
    v_mfma_f32_16x16x32_bf16 v[196:199], v[72:75], v[24:27], v[196:199]
    ds_read_b128 v[72:75], v3 offset:2048
    v_max_f32 v96, 0, v96
    s_waitcnt lgkmcnt(8)
    v_mfma_f32_16x16x32_bf16 v[128:131], v[76:79], v[40:43], v[128:131]
    v_max_f32 v97, 0, v97
    v_max_f32 v98, 0, v98
    v_mfma_f32_16x16x32_bf16 v[136:139], v[76:79], v[44:47], v[136:139]
    v_max_f32 v99, 0, v99
    v_max_f32 v100, 0, v100
    v_mfma_f32_16x16x32_bf16 v[144:147], v[76:79], v[48:51], v[144:147]
    v_max_f32 v101, 0, v101
    v_max_f32 v102, 0, v102
    v_mfma_f32_16x16x32_bf16 v[152:155], v[76:79], v[52:55], v[152:155]
    ds_read_b128 v[76:79], v4 offset:0
    v_max_f32 v103, 0, v103
    s_waitcnt lgkmcnt(7)
    v_mfma_f32_16x16x32_bf16 v[216:219], v[56:59], v[52:55], v[216:219]
    v_mul_f32 v160, v160, v96
    v_mul_f32 v161, v161, v97
    v_mfma_f32_16x16x32_bf16 v[208:211], v[56:59], v[48:51], v[208:211]
    v_mul_f32 v162, v162, v98
    v_mul_f32 v163, v163, v99
    v_mfma_f32_16x16x32_bf16 v[200:203], v[56:59], v[44:47], v[200:203]
    v_mul_f32 v164, v164, v100
    v_mul_f32 v165, v165, v101
    v_mfma_f32_16x16x32_bf16 v[192:195], v[56:59], v[40:43], v[192:195]
    ds_read_b128 v[56:59], v4 offset:2048
    v_mul_f32 v166, v166, v102
    s_waitcnt lgkmcnt(6)
    v_mfma_f32_16x16x32_bf16 v[132:135], v[60:63], v[40:43], v[132:135]
    v_mul_f32 v167, v167, v103
    v_cvt_pk_bf16_f32 v96, v160, v161
    v_mfma_f32_16x16x32_bf16 v[140:143], v[60:63], v[44:47], v[140:143]
    v_cvt_pk_bf16_f32 v97, v162, v163
    v_cvt_pk_bf16_f32 v98, v164, v165
    v_mfma_f32_16x16x32_bf16 v[148:151], v[60:63], v[48:51], v[148:151]
    v_cvt_pk_bf16_f32 v99, v166, v167
    buffer_store_dwordx4 v[96:99], v9, s[64:67], s56 offen offset:0 sc1
    v_mfma_f32_16x16x32_bf16 v[156:159], v[60:63], v[52:55], v[156:159]
    v_fmac_f32 v104, v21, v80
    v_fmac_f32 v105, v21, v81
    s_waitcnt lgkmcnt(4)
    v_mfma_f32_16x16x32_bf16 v[220:223], v[64:67], v[52:55], v[220:223]
    v_fmac_f32 v106, v21, v82
    v_fmac_f32 v107, v21, v83
    v_mfma_f32_16x16x32_bf16 v[212:215], v[64:67], v[48:51], v[212:215]
    v_fmac_f32 v108, v21, v84
    v_fmac_f32 v109, v21, v85
    v_mfma_f32_16x16x32_bf16 v[204:207], v[64:67], v[44:47], v[204:207]
    v_fmac_f32 v110, v21, v86
    v_fmac_f32 v111, v21, v87
    v_mfma_f32_16x16x32_bf16 v[196:199], v[64:67], v[40:43], v[196:199]
    v_fmac_f32 v168, v21, v88
    v_fmac_f32 v169, v21, v89
    s_waitcnt lgkmcnt(3)
    v_mfma_f32_16x16x32_bf16 v[224:227], v[24:27], v[68:71], v[224:227]
    v_fmac_f32 v170, v21, v90
    v_fmac_f32 v171, v21, v91
    v_mfma_f32_16x16x32_bf16 v[228:231], v[28:31], v[68:71], v[228:231]
    v_fmac_f32 v172, v21, v92
    v_fmac_f32 v173, v21, v93
    v_mfma_f32_16x16x32_bf16 v[232:235], v[32:35], v[68:71], v[232:235]
    v_fmac_f32 v174, v21, v94
    v_fmac_f32 v175, v21, v95
    v_mfma_f32_16x16x32_bf16 v[236:239], v[36:39], v[68:71], v[236:239]
    v_max_f32 v104, 0, v104
    v_max_f32 v105, 0, v105
    s_waitcnt lgkmcnt(2)
    v_mfma_f32_16x16x32_bf16 v[252:255], v[36:39], v[72:75], v[252:255]
    v_max_f32 v106, 0, v106
    v_max_f32 v107, 0, v107
    v_mfma_f32_16x16x32_bf16 v[248:251], v[32:35], v[72:75], v[248:251]
    v_max_f32 v108, 0, v108
    v_max_f32 v109, 0, v109
    v_mfma_f32_16x16x32_bf16 v[244:247], v[28:31], v[72:75], v[244:247]
    v_max_f32 v110, 0, v110
    v_max_f32 v111, 0, v111
    v_mfma_f32_16x16x32_bf16 v[240:243], v[24:27], v[72:75], v[240:243]
    v_mul_f32 v168, v168, v104
    v_mul_f32 v169, v169, v105
    ds_read_b128 v[24:27], v13 offset:128
    ds_read_b128 v[28:31], v13 offset:192
    ds_read_b128 v[32:35], v13 offset:384
    ds_read_b128 v[36:39], v13 offset:448
    s_waitcnt lgkmcnt(5)
    v_mfma_f32_16x16x32_bf16 v[224:227], v[40:43], v[76:79], v[224:227]
    v_mul_f32 v170, v170, v106
    v_mul_f32 v171, v171, v107
    v_mfma_f32_16x16x32_bf16 v[228:231], v[44:47], v[76:79], v[228:231]
    v_mul_f32 v172, v172, v108
    v_mul_f32 v173, v173, v109
    v_mfma_f32_16x16x32_bf16 v[232:235], v[48:51], v[76:79], v[232:235]
    v_mul_f32 v174, v174, v110
    v_mul_f32 v175, v175, v111
    v_mfma_f32_16x16x32_bf16 v[236:239], v[52:55], v[76:79], v[236:239]
    v_cvt_pk_bf16_f32 v104, v168, v169
    v_cvt_pk_bf16_f32 v105, v170, v171
    s_waitcnt lgkmcnt(4)
    s_barrier
    v_mfma_f32_16x16x32_bf16 v[252:255], v[52:55], v[56:59], v[252:255]
    v_cvt_pk_bf16_f32 v106, v172, v173
    v_cvt_pk_bf16_f32 v107, v174, v175
    v_mfma_f32_16x16x32_bf16 v[248:251], v[48:51], v[56:59], v[248:251]
    buffer_store_dwordx4 v[104:107], v9, s[64:67], s56 offen offset:256 sc1
    v_mfma_f32_16x16x32_bf16 v[244:247], v[44:47], v[56:59], v[244:247]
    v_mfma_f32_16x16x32_bf16 v[240:243], v[40:43], v[56:59], v[240:243]
    v_add_u32 v1, 0, v19
    v_xor_b32 v2, 64, v1
    v_add_u32 v3, 53248, v19
    v_xor_b32 v4, 64, v3
    v_add_u32 v5, 106496, v19
    v_xor_b32 v6, 64, v5
    s_waitcnt lgkmcnt(0)
    v_pk_fma_f32 v[112:113], v[22:23], v[80:81], v[112:113] op_sel:[0,0,0] op_sel_hi:[0,1,1]
    ds_write_b128 v15, v[224:227] offset:0
    v_pk_fma_f32 v[114:115], v[22:23], v[82:83], v[114:115] op_sel:[0,0,0] op_sel_hi:[0,1,1]
    ds_write_b128 v15, v[228:231] offset:1024
    v_pk_fma_f32 v[116:117], v[22:23], v[84:85], v[116:117] op_sel:[0,0,0] op_sel_hi:[0,1,1]
    ds_write_b128 v15, v[232:235] offset:2048
    v_pk_fma_f32 v[118:119], v[22:23], v[86:87], v[118:119] op_sel:[0,0,0] op_sel_hi:[0,1,1]
    ds_write_b128 v15, v[236:239] offset:3072
    v_pk_fma_f32 v[176:177], v[22:23], v[88:89], v[176:177] op_sel:[0,0,0] op_sel_hi:[0,1,1]
    v_max_f32 v112, 0, v112
    v_max_f32 v113, 0, v113
    v_pk_fma_f32 v[178:179], v[22:23], v[90:91], v[178:179] op_sel:[0,0,0] op_sel_hi:[0,1,1]
    v_max_f32 v114, 0, v114
    v_max_f32 v115, 0, v115
    v_pk_fma_f32 v[180:181], v[22:23], v[92:93], v[180:181] op_sel:[0,0,0] op_sel_hi:[0,1,1]
    v_max_f32 v116, 0, v116
    v_max_f32 v117, 0, v117
    v_pk_fma_f32 v[182:183], v[22:23], v[94:95], v[182:183] op_sel:[0,0,0] op_sel_hi:[0,1,1]
    v_max_f32 v118, 0, v118
    v_max_f32 v119, 0, v119
    v_pk_mul_f32 v[176:177], v[176:177], v[112:113]
    v_pk_mul_f32 v[178:179], v[178:179], v[114:115]
    v_pk_mul_f32 v[180:181], v[180:181], v[116:117]
    v_pk_mul_f32 v[182:183], v[182:183], v[118:119]
    v_cvt_pk_bf16_f32 v112, v176, v177
    v_cvt_pk_bf16_f32 v113, v178, v179
    v_cvt_pk_bf16_f32 v114, v180, v181
    v_cvt_pk_bf16_f32 v115, v182, v183
    buffer_store_dwordx4 v[112:115], v9, s[64:67], s57 offen offset:0 sc1
    v_pk_fma_f32 v[120:121], v[22:23], v[80:81], v[120:121] op_sel:[1,0,0] op_sel_hi:[1,1,1]
    ds_write_b128 v15, v[240:243] offset:4096
    v_pk_fma_f32 v[122:123], v[22:23], v[82:83], v[122:123] op_sel:[1,0,0] op_sel_hi:[1,1,1]
    ds_write_b128 v15, v[244:247] offset:5120
    v_pk_fma_f32 v[124:125], v[22:23], v[84:85], v[124:125] op_sel:[1,0,0] op_sel_hi:[1,1,1]
    ds_write_b128 v15, v[248:251] offset:6144
    v_pk_fma_f32 v[126:127], v[22:23], v[86:87], v[126:127] op_sel:[1,0,0] op_sel_hi:[1,1,1]
    ds_write_b128 v15, v[252:255] offset:7168
    v_pk_fma_f32 v[184:185], v[22:23], v[88:89], v[184:185] op_sel:[1,0,0] op_sel_hi:[1,1,1]
    v_max_f32 v120, 0, v120
    v_max_f32 v121, 0, v121
    v_pk_fma_f32 v[186:187], v[22:23], v[90:91], v[186:187] op_sel:[1,0,0] op_sel_hi:[1,1,1]
    v_max_f32 v122, 0, v122
    v_max_f32 v123, 0, v123
    v_pk_fma_f32 v[188:189], v[22:23], v[92:93], v[188:189] op_sel:[1,0,0] op_sel_hi:[1,1,1]
    v_max_f32 v124, 0, v124
    v_max_f32 v125, 0, v125
    v_pk_fma_f32 v[190:191], v[22:23], v[94:95], v[190:191] op_sel:[1,0,0] op_sel_hi:[1,1,1]
    v_max_f32 v126, 0, v126
    v_max_f32 v127, 0, v127
    v_pk_mul_f32 v[184:185], v[184:185], v[120:121]
    v_pk_mul_f32 v[186:187], v[186:187], v[122:123]
    v_pk_mul_f32 v[188:189], v[188:189], v[124:125]
    v_pk_mul_f32 v[190:191], v[190:191], v[126:127]
    v_cvt_pk_bf16_f32 v120, v184, v185
    v_cvt_pk_bf16_f32 v121, v186, v187
    v_cvt_pk_bf16_f32 v122, v188, v189
    v_cvt_pk_bf16_f32 v123, v190, v191
    s_waitcnt lgkmcnt(0)
    s_barrier
    buffer_store_dwordx4 v[120:123], v9, s[64:67], s57 offen offset:256 sc1
    v_pk_fma_f32 v[128:129], v[20:21], v[24:25], v[128:129] op_sel:[0,0,0] op_sel_hi:[0,1,1]
    v_pk_fma_f32 v[130:131], v[20:21], v[26:27], v[130:131] op_sel:[0,0,0] op_sel_hi:[0,1,1]
    v_pk_fma_f32 v[132:133], v[20:21], v[28:29], v[132:133] op_sel:[0,0,0] op_sel_hi:[0,1,1]
    v_pk_fma_f32 v[134:135], v[20:21], v[30:31], v[134:135] op_sel:[0,0,0] op_sel_hi:[0,1,1]
    v_pk_fma_f32 v[192:193], v[20:21], v[32:33], v[192:193] op_sel:[0,0,0] op_sel_hi:[0,1,1]
    v_max_f32 v128, 0, v128
    v_max_f32 v129, 0, v129
    v_pk_fma_f32 v[194:195], v[20:21], v[34:35], v[194:195] op_sel:[0,0,0] op_sel_hi:[0,1,1]
    v_max_f32 v130, 0, v130
    v_max_f32 v131, 0, v131
    v_pk_fma_f32 v[196:197], v[20:21], v[36:37], v[196:197] op_sel:[0,0,0] op_sel_hi:[0,1,1]
    v_max_f32 v132, 0, v132
    v_max_f32 v133, 0, v133
    v_pk_fma_f32 v[198:199], v[20:21], v[38:39], v[198:199] op_sel:[0,0,0] op_sel_hi:[0,1,1]
    v_max_f32 v134, 0, v134
    v_max_f32 v135, 0, v135
    v_pk_mul_f32 v[192:193], v[192:193], v[128:129]
    v_pk_mul_f32 v[194:195], v[194:195], v[130:131]
    v_pk_mul_f32 v[196:197], v[196:197], v[132:133]
    v_pk_mul_f32 v[198:199], v[198:199], v[134:135]
    v_cvt_pk_bf16_f32 v128, v192, v193
    v_cvt_pk_bf16_f32 v129, v194, v195
    v_cvt_pk_bf16_f32 v130, v196, v197
    v_cvt_pk_bf16_f32 v131, v198, v199
    buffer_store_dwordx4 v[128:131], v9, s[64:67], s56 offen offset:2048 sc1
    v_pk_fma_f32 v[136:137], v[20:21], v[24:25], v[136:137] op_sel:[1,0,0] op_sel_hi:[1,1,1]
    v_pk_fma_f32 v[138:139], v[20:21], v[26:27], v[138:139] op_sel:[1,0,0] op_sel_hi:[1,1,1]
    v_pk_fma_f32 v[140:141], v[20:21], v[28:29], v[140:141] op_sel:[1,0,0] op_sel_hi:[1,1,1]
    v_pk_fma_f32 v[142:143], v[20:21], v[30:31], v[142:143] op_sel:[1,0,0] op_sel_hi:[1,1,1]
    v_pk_fma_f32 v[200:201], v[20:21], v[32:33], v[200:201] op_sel:[1,0,0] op_sel_hi:[1,1,1]
    v_max_f32 v136, 0, v136
    v_max_f32 v137, 0, v137
    v_pk_fma_f32 v[202:203], v[20:21], v[34:35], v[202:203] op_sel:[1,0,0] op_sel_hi:[1,1,1]
    v_max_f32 v138, 0, v138
    v_max_f32 v139, 0, v139
    v_pk_fma_f32 v[204:205], v[20:21], v[36:37], v[204:205] op_sel:[1,0,0] op_sel_hi:[1,1,1]
    v_max_f32 v140, 0, v140
    v_max_f32 v141, 0, v141
    v_pk_fma_f32 v[206:207], v[20:21], v[38:39], v[206:207] op_sel:[1,0,0] op_sel_hi:[1,1,1]
    v_max_f32 v142, 0, v142
    v_max_f32 v143, 0, v143
    v_pk_mul_f32 v[200:201], v[200:201], v[136:137]
    v_pk_mul_f32 v[202:203], v[202:203], v[138:139]
    v_pk_mul_f32 v[204:205], v[204:205], v[140:141]
    v_pk_mul_f32 v[206:207], v[206:207], v[142:143]
    v_cvt_pk_bf16_f32 v136, v200, v201
    v_cvt_pk_bf16_f32 v137, v202, v203
    v_cvt_pk_bf16_f32 v138, v204, v205
    v_cvt_pk_bf16_f32 v139, v206, v207
    buffer_store_dwordx4 v[136:139], v9, s[64:67], s56 offen offset:2304 sc1
    v_pk_fma_f32 v[144:145], v[22:23], v[24:25], v[144:145] op_sel:[0,0,0] op_sel_hi:[0,1,1]
    v_pk_fma_f32 v[146:147], v[22:23], v[26:27], v[146:147] op_sel:[0,0,0] op_sel_hi:[0,1,1]
    v_pk_fma_f32 v[148:149], v[22:23], v[28:29], v[148:149] op_sel:[0,0,0] op_sel_hi:[0,1,1]
    v_pk_fma_f32 v[150:151], v[22:23], v[30:31], v[150:151] op_sel:[0,0,0] op_sel_hi:[0,1,1]
    v_pk_fma_f32 v[208:209], v[22:23], v[32:33], v[208:209] op_sel:[0,0,0] op_sel_hi:[0,1,1]
    v_max_f32 v144, 0, v144
    v_max_f32 v145, 0, v145
    v_pk_fma_f32 v[210:211], v[22:23], v[34:35], v[210:211] op_sel:[0,0,0] op_sel_hi:[0,1,1]
    v_max_f32 v146, 0, v146
    v_max_f32 v147, 0, v147
    v_pk_fma_f32 v[212:213], v[22:23], v[36:37], v[212:213] op_sel:[0,0,0] op_sel_hi:[0,1,1]
    v_max_f32 v148, 0, v148
    v_max_f32 v149, 0, v149
    v_pk_fma_f32 v[214:215], v[22:23], v[38:39], v[214:215] op_sel:[0,0,0] op_sel_hi:[0,1,1]
    v_max_f32 v150, 0, v150
    v_max_f32 v151, 0, v151
    v_pk_mul_f32 v[208:209], v[208:209], v[144:145]
    v_pk_mul_f32 v[210:211], v[210:211], v[146:147]
    v_pk_mul_f32 v[212:213], v[212:213], v[148:149]
    v_pk_mul_f32 v[214:215], v[214:215], v[150:151]
    v_cvt_pk_bf16_f32 v144, v208, v209
    v_cvt_pk_bf16_f32 v145, v210, v211
    v_cvt_pk_bf16_f32 v146, v212, v213
    v_cvt_pk_bf16_f32 v147, v214, v215
    buffer_store_dwordx4 v[144:147], v9, s[64:67], s57 offen offset:2048 sc1
    v_pk_fma_f32 v[152:153], v[22:23], v[24:25], v[152:153] op_sel:[1,0,0] op_sel_hi:[1,1,1]
    v_pk_fma_f32 v[154:155], v[22:23], v[26:27], v[154:155] op_sel:[1,0,0] op_sel_hi:[1,1,1]
    v_pk_fma_f32 v[156:157], v[22:23], v[28:29], v[156:157] op_sel:[1,0,0] op_sel_hi:[1,1,1]
    v_pk_fma_f32 v[158:159], v[22:23], v[30:31], v[158:159] op_sel:[1,0,0] op_sel_hi:[1,1,1]
    v_pk_fma_f32 v[216:217], v[22:23], v[32:33], v[216:217] op_sel:[1,0,0] op_sel_hi:[1,1,1]
    v_max_f32 v152, 0, v152
    v_max_f32 v153, 0, v153
    v_pk_fma_f32 v[218:219], v[22:23], v[34:35], v[218:219] op_sel:[1,0,0] op_sel_hi:[1,1,1]
    v_max_f32 v154, 0, v154
    v_max_f32 v155, 0, v155
    v_pk_fma_f32 v[220:221], v[22:23], v[36:37], v[220:221] op_sel:[1,0,0] op_sel_hi:[1,1,1]
    v_max_f32 v156, 0, v156
    v_max_f32 v157, 0, v157
    v_pk_fma_f32 v[222:223], v[22:23], v[38:39], v[222:223] op_sel:[1,0,0] op_sel_hi:[1,1,1]
    v_max_f32 v158, 0, v158
    v_max_f32 v159, 0, v159
    v_pk_mul_f32 v[216:217], v[216:217], v[152:153]
    v_pk_mul_f32 v[218:219], v[218:219], v[154:155]
    v_pk_mul_f32 v[220:221], v[220:221], v[156:157]
    v_pk_mul_f32 v[222:223], v[222:223], v[158:159]
    v_cvt_pk_bf16_f32 v152, v216, v217
    v_cvt_pk_bf16_f32 v153, v218, v219
    v_cvt_pk_bf16_f32 v154, v220, v221
    v_cvt_pk_bf16_f32 v155, v222, v223
    buffer_store_dwordx4 v[152:155], v9, s[64:67], s57 offen offset:2304 sc1
    ds_read_b64_tr_b16 v[160:161], v3 offset:0
    ds_read_b64_tr_b16 v[162:163], v3 offset:1024
    ds_read_b64_tr_b16 v[164:165], v4 offset:0
    ds_read_b64_tr_b16 v[166:167], v4 offset:1024
    ds_read_b64_tr_b16 v[168:169], v3 offset:2048
    ds_read_b64_tr_b16 v[170:171], v3 offset:3072
    ds_read_b64_tr_b16 v[172:173], v4 offset:2048
    ds_read_b64_tr_b16 v[174:175], v4 offset:3072
    ds_read_b64_tr_b16 v[176:177], v3 offset:4096
    ds_read_b64_tr_b16 v[178:179], v3 offset:5120
    ds_read_b64_tr_b16 v[180:181], v4 offset:4096
    ds_read_b64_tr_b16 v[182:183], v4 offset:5120
    ds_read_b64_tr_b16 v[184:185], v3 offset:6144
    ds_read_b64_tr_b16 v[186:187], v3 offset:7168
    ds_read_b64_tr_b16 v[188:189], v4 offset:6144
    ds_read_b64_tr_b16 v[190:191], v4 offset:7168
    ds_read_b64_tr_b16 v[192:193], v3 offset:8192
    ds_read_b64_tr_b16 v[194:195], v3 offset:9216
    ds_read_b64_tr_b16 v[196:197], v4 offset:8192
    ds_read_b64_tr_b16 v[198:199], v4 offset:9216
    ds_read_b64_tr_b16 v[200:201], v3 offset:10240
    ds_read_b64_tr_b16 v[202:203], v3 offset:11264
    ds_read_b64_tr_b16 v[204:205], v4 offset:10240
    ds_read_b64_tr_b16 v[206:207], v4 offset:11264
    ds_read_b64_tr_b16 v[208:209], v5 offset:0
    ds_read_b64_tr_b16 v[210:211], v5 offset:1024
    ds_read_b64_tr_b16 v[212:213], v6 offset:0
    ds_read_b64_tr_b16 v[214:215], v6 offset:1024
    ds_read_b64_tr_b16 v[216:217], v5 offset:2048
    ds_read_b64_tr_b16 v[218:219], v5 offset:3072
    ds_read_b64_tr_b16 v[220:221], v6 offset:2048
    ds_read_b64_tr_b16 v[222:223], v6 offset:3072
    ds_read_b64_tr_b16 v[224:225], v5 offset:4096
    ds_read_b64_tr_b16 v[226:227], v5 offset:5120
    ds_read_b64_tr_b16 v[228:229], v6 offset:4096
    ds_read_b64_tr_b16 v[230:231], v6 offset:5120
    ds_read_b64_tr_b16 v[232:233], v5 offset:6144
    ds_read_b64_tr_b16 v[234:235], v5 offset:7168
    ds_read_b64_tr_b16 v[236:237], v6 offset:6144
    ds_read_b64_tr_b16 v[238:239], v6 offset:7168
    ds_read_b64_tr_b16 v[240:241], v5 offset:8192
    ds_read_b64_tr_b16 v[242:243], v5 offset:9216
    ds_read_b64_tr_b16 v[244:245], v6 offset:8192
    ds_read_b64_tr_b16 v[246:247], v6 offset:9216
    ds_read_b64_tr_b16 v[248:249], v5 offset:10240
    ds_read_b64_tr_b16 v[250:251], v5 offset:11264
    ds_read_b64_tr_b16 v[252:253], v6 offset:10240
    ds_read_b64_tr_b16 v[254:255], v6 offset:11264
    s_waitcnt vmcnt(0)
    s_setprio 3
    s_mov_b64 exec, 1
    buffer_store_dword v10, v14, s[64:67], 0 offen sc1
    s_mov_b64 exec, -1
    s_waitcnt lgkmcnt(0)
    s_barrier
    s_mov_b32 s73, 0
L_pf_spin_7:
    s_load_dwordx8 s[16:23], s[46:47], s55 glc
    s_waitcnt lgkmcnt(0)
    s_and_b64 s[16:17], s[16:17], s[18:19]
    s_and_b64 s[16:17], s[16:17], s[20:21]
    s_and_b32 s16, s16, s17
    s_and_b32 s16, s16, s22
    s_cmp_eq_u32 s16, 1
    s_cbranch_scc1 L_pf_ok_8
    s_add_u32 s73, s73, 1
    s_cmp_lt_u32 s73, 1048576
    s_sleep 2
    s_cbranch_scc1 L_pf_spin_7
L_pf_ok_8:
    s_setprio 2
    s_lshl_b32 s11, s60, 12
    s_add_u32 s54, s11, s52
    s_add_u32 s53, s11, s51
    s_add_u32 s60, s60, 1
    s_cmp_eq_u32 s60, 7
    s_cselect_b32 s60, 0, s60
    buffer_load_dwordx4 v[24:27], v11, s[64:67], s54 offen offset:0 sc1
    buffer_load_dwordx4 v[28:31], v11, s[64:67], s53 offen offset:0 sc1
    buffer_load_dwordx4 v[32:35], v11, s[64:67], s54 offen offset:1024 sc1
    buffer_load_dwordx4 v[36:39], v11, s[64:67], s53 offen offset:1024 sc1
    buffer_load_dwordx4 v[40:43], v11, s[64:67], s54 offen offset:2048 sc1
    buffer_load_dwordx4 v[44:47], v11, s[64:67], s53 offen offset:2048 sc1
    buffer_load_dwordx4 v[48:51], v11, s[64:67], s54 offen offset:3072 sc1
    buffer_load_dwordx4 v[52:55], v11, s[64:67], s53 offen offset:3072 sc1
    s_lshl_b32 s11, s60, 12
    s_add_u32 s54, s11, s52
    s_add_u32 s53, s11, s51
    s_add_u32 s60, s60, 1
    s_cmp_eq_u32 s60, 7
    s_cselect_b32 s60, 0, s60
    buffer_load_dwordx4 v[56:59], v11, s[64:67], s54 offen offset:0 sc1
    buffer_load_dwordx4 v[60:63], v11, s[64:67], s53 offen offset:0 sc1
    buffer_load_dwordx4 v[64:67], v11, s[64:67], s54 offen offset:1024 sc1
    buffer_load_dwordx4 v[68:71], v11, s[64:67], s53 offen offset:1024 sc1
    buffer_load_dwordx4 v[72:75], v11, s[64:67], s54 offen offset:2048 sc1
    buffer_load_dwordx4 v[76:79], v11, s[64:67], s53 offen offset:2048 sc1
    buffer_load_dwordx4 v[80:83], v11, s[64:67], s54 offen offset:3072 sc1
    buffer_load_dwordx4 v[84:87], v11, s[64:67], s53 offen offset:3072 sc1
    s_lshl_b32 s11, s60, 12
    s_add_u32 s54, s11, s52
    s_add_u32 s53, s11, s51
    s_add_u32 s60, s60, 1
    s_cmp_eq_u32 s60, 7
    s_cselect_b32 s60, 0, s60
    buffer_load_dwordx4 v[88:91], v11, s[64:67], s54 offen offset:0 sc1
    buffer_load_dwordx4 v[92:95], v11, s[64:67], s53 offen offset:0 sc1
    s_waitcnt vmcnt(17)
    v_mfma_f32_32x32x16_bf16 v[96:111], v[24:27], v[160:163], 0
    v_mfma_f32_32x32x16_bf16 v[112:127], v[24:27], v[164:167], 0
    buffer_load_dwordx4 v[24:27], v11, s[64:67], s54 offen offset:1024 sc1
    s_waitcnt vmcnt(17)
    v_mfma_f32_32x32x16_bf16 v[128:143], v[28:31], v[160:163], 0
    v_mfma_f32_32x32x16_bf16 v[144:159], v[28:31], v[164:167], 0
    buffer_load_dwordx4 v[28:31], v11, s[64:67], s53 offen offset:1024 sc1
    s_waitcnt vmcnt(17)
    v_mfma_f32_32x32x16_bf16 v[96:111], v[32:35], v[168:171], v[96:111]
    v_mfma_f32_32x32x16_bf16 v[112:127], v[32:35], v[172:175], v[112:127]
    buffer_load_dwordx4 v[32:35], v11, s[64:67], s54 offen offset:2048 sc1
    s_waitcnt vmcnt(17)
    v_mfma_f32_32x32x16_bf16 v[128:143], v[36:39], v[168:171], v[128:143]
    v_mfma_f32_32x32x16_bf16 v[144:159], v[36:39], v[172:175], v[144:159]
    buffer_load_dwordx4 v[36:39], v11, s[64:67], s53 offen offset:2048 sc1
    s_waitcnt vmcnt(17)
    v_mfma_f32_32x32x16_bf16 v[96:111], v[40:43], v[176:179], v[96:111]
    v_mfma_f32_32x32x16_bf16 v[112:127], v[40:43], v[180:183], v[112:127]
    buffer_load_dwordx4 v[40:43], v11, s[64:67], s54 offen offset:3072 sc1
    s_waitcnt vmcnt(17)
    v_mfma_f32_32x32x16_bf16 v[128:143], v[44:47], v[176:179], v[128:143]
    v_mfma_f32_32x32x16_bf16 v[144:159], v[44:47], v[180:183], v[144:159]
    buffer_load_dwordx4 v[44:47], v11, s[64:67], s53 offen offset:3072 sc1
    s_waitcnt vmcnt(17)
    v_mfma_f32_32x32x16_bf16 v[96:111], v[48:51], v[184:187], v[96:111]
    v_mfma_f32_32x32x16_bf16 v[112:127], v[48:51], v[188:191], v[112:127]
    s_lshl_b32 s11, s60, 12
    s_add_u32 s54, s11, s52
    s_add_u32 s53, s11, s51
    s_add_u32 s60, s60, 1
    s_cmp_eq_u32 s60, 7
    s_cselect_b32 s60, 0, s60
    buffer_load_dwordx4 v[48:51], v11, s[64:67], s54 offen offset:0 sc1
    s_waitcnt vmcnt(17)
    v_mfma_f32_32x32x16_bf16 v[128:143], v[52:55], v[184:187], v[128:143]
    v_mfma_f32_32x32x16_bf16 v[144:159], v[52:55], v[188:191], v[144:159]
    buffer_load_dwordx4 v[52:55], v11, s[64:67], s53 offen offset:0 sc1
    s_waitcnt vmcnt(17)
    v_mfma_f32_32x32x16_bf16 v[96:111], v[56:59], v[192:195], v[96:111]
    v_mfma_f32_32x32x16_bf16 v[112:127], v[56:59], v[196:199], v[112:127]
    buffer_load_dwordx4 v[56:59], v11, s[64:67], s54 offen offset:1024 sc1
    s_waitcnt vmcnt(17)
    v_mfma_f32_32x32x16_bf16 v[128:143], v[60:63], v[192:195], v[128:143]
    v_mfma_f32_32x32x16_bf16 v[144:159], v[60:63], v[196:199], v[144:159]
    buffer_load_dwordx4 v[60:63], v11, s[64:67], s53 offen offset:1024 sc1
    s_waitcnt vmcnt(17)
    v_mfma_f32_32x32x16_bf16 v[96:111], v[64:67], v[200:203], v[96:111]
    v_mfma_f32_32x32x16_bf16 v[112:127], v[64:67], v[204:207], v[112:127]
    buffer_load_dwordx4 v[64:67], v11, s[64:67], s54 offen offset:2048 sc1
    s_waitcnt vmcnt(17)
    v_mfma_f32_32x32x16_bf16 v[128:143], v[68:71], v[200:203], v[128:143]
    v_mfma_f32_32x32x16_bf16 v[144:159], v[68:71], v[204:207], v[144:159]
    buffer_load_dwordx4 v[68:71], v11, s[64:67], s53 offen offset:2048 sc1
    s_waitcnt vmcnt(17)
    v_mfma_f32_32x32x16_bf16 v[96:111], v[72:75], v[208:211], v[96:111]
    v_mfma_f32_32x32x16_bf16 v[112:127], v[72:75], v[212:215], v[112:127]
    buffer_load_dwordx4 v[72:75], v11, s[64:67], s54 offen offset:3072 sc1
    s_waitcnt vmcnt(17)
    v_mfma_f32_32x32x16_bf16 v[128:143], v[76:79], v[208:211], v[128:143]
    v_mfma_f32_32x32x16_bf16 v[144:159], v[76:79], v[212:215], v[144:159]
    buffer_load_dwordx4 v[76:79], v11, s[64:67], s53 offen offset:3072 sc1
    s_waitcnt vmcnt(17)
    v_mfma_f32_32x32x16_bf16 v[96:111], v[80:83], v[216:219], v[96:111]
    v_mfma_f32_32x32x16_bf16 v[112:127], v[80:83], v[220:223], v[112:127]
    s_lshl_b32 s11, s60, 12
    s_add_u32 s54, s11, s52
    s_add_u32 s53, s11, s51
    s_add_u32 s60, s60, 1
    s_cmp_eq_u32 s60, 7
    s_cselect_b32 s60, 0, s60
    buffer_load_dwordx4 v[80:83], v11, s[64:67], s54 offen offset:0 sc1
    s_waitcnt vmcnt(17)
    v_mfma_f32_32x32x16_bf16 v[128:143], v[84:87], v[216:219], v[128:143]
    v_mfma_f32_32x32x16_bf16 v[144:159], v[84:87], v[220:223], v[144:159]
    buffer_load_dwordx4 v[84:87], v11, s[64:67], s53 offen offset:0 sc1
    s_waitcnt vmcnt(17)
    ds_read_b32 v8, v18
    v_mfma_f32_32x32x16_bf16 v[96:111], v[88:91], v[224:227], v[96:111]
    v_mfma_f32_32x32x16_bf16 v[112:127], v[88:91], v[228:231], v[112:127]
    buffer_load_dwordx4 v[88:91], v11, s[64:67], s54 offen offset:1024 sc1
    s_waitcnt vmcnt(17)
    v_mfma_f32_32x32x16_bf16 v[128:143], v[92:95], v[224:227], v[128:143]
    v_mfma_f32_32x32x16_bf16 v[144:159], v[92:95], v[228:231], v[144:159]
    buffer_load_dwordx4 v[92:95], v11, s[64:67], s53 offen offset:1024 sc1
    s_mov_b32 s73, 0
L_c_r12:
    s_waitcnt lgkmcnt(0)
    v_readfirstlane_b32 s11, v8
    s_nop 0
    s_cmp_ge_u32 s11, 1
    s_cbranch_scc1 L_c_r12ok
    s_add_u32 s73, s73, 1
    s_cmp_ge_u32 s73, 1048576
    s_cbranch_scc1 L_c_r12ok
    s_sleep 1
    ds_read_b32 v8, v18 offset:0
    s_branch L_c_r12
L_c_r12ok:
    ds_read_b64_tr_b16 v[160:161], v1 offset:0
    ds_read_b64_tr_b16 v[162:163], v1 offset:1024
    ds_read_b64_tr_b16 v[164:165], v2 offset:0
    ds_read_b64_tr_b16 v[166:167], v2 offset:1024
    s_waitcnt vmcnt(17)
    v_mfma_f32_32x32x16_bf16 v[96:111], v[24:27], v[232:235], v[96:111]
    v_mfma_f32_32x32x16_bf16 v[112:127], v[24:27], v[236:239], v[112:127]
    buffer_load_dwordx4 v[24:27], v11, s[64:67], s54 offen offset:2048 sc1
    s_waitcnt vmcnt(17)
    v_mfma_f32_32x32x16_bf16 v[128:143], v[28:31], v[232:235], v[128:143]
    v_mfma_f32_32x32x16_bf16 v[144:159], v[28:31], v[236:239], v[144:159]
    buffer_load_dwordx4 v[28:31], v11, s[64:67], s53 offen offset:2048 sc1
    ds_read_b64_tr_b16 v[168:169], v1 offset:2048
    ds_read_b64_tr_b16 v[170:171], v1 offset:3072
    ds_read_b64_tr_b16 v[172:173], v2 offset:2048
    ds_read_b64_tr_b16 v[174:175], v2 offset:3072
    s_waitcnt vmcnt(17)
    v_mfma_f32_32x32x16_bf16 v[96:111], v[32:35], v[240:243], v[96:111]
    v_mfma_f32_32x32x16_bf16 v[112:127], v[32:35], v[244:247], v[112:127]
    buffer_load_dwordx4 v[32:35], v11, s[64:67], s54 offen offset:3072 sc1
    s_waitcnt vmcnt(17)
    v_mfma_f32_32x32x16_bf16 v[128:143], v[36:39], v[240:243], v[128:143]
    v_mfma_f32_32x32x16_bf16 v[144:159], v[36:39], v[244:247], v[144:159]
    buffer_load_dwordx4 v[36:39], v11, s[64:67], s53 offen offset:3072 sc1
    ds_read_b64_tr_b16 v[176:177], v1 offset:4096
    ds_read_b64_tr_b16 v[178:179], v1 offset:5120
    ds_read_b64_tr_b16 v[180:181], v2 offset:4096
    ds_read_b64_tr_b16 v[182:183], v2 offset:5120
    s_waitcnt vmcnt(17)
    v_mfma_f32_32x32x16_bf16 v[96:111], v[40:43], v[248:251], v[96:111]
    v_mfma_f32_32x32x16_bf16 v[112:127], v[40:43], v[252:255], v[112:127]
    s_lshl_b32 s11, s60, 12
    s_add_u32 s54, s11, s52
    s_add_u32 s53, s11, s51
    s_add_u32 s60, s60, 1
    s_cmp_eq_u32 s60, 7
    s_cselect_b32 s60, 0, s60
    buffer_load_dwordx4 v[40:43], v11, s[64:67], s54 offen offset:0 sc1
    s_waitcnt vmcnt(17)
    v_mfma_f32_32x32x16_bf16 v[128:143], v[44:47], v[248:251], v[128:143]
    v_mfma_f32_32x32x16_bf16 v[144:159], v[44:47], v[252:255], v[144:159]
    buffer_load_dwordx4 v[44:47], v11, s[64:67], s53 offen offset:0 sc1
    ds_read_b64_tr_b16 v[184:185], v1 offset:6144
    ds_read_b64_tr_b16 v[186:187], v1 offset:7168
    ds_read_b64_tr_b16 v[188:189], v2 offset:6144
    ds_read_b64_tr_b16 v[190:191], v2 offset:7168
    s_waitcnt vmcnt(17) lgkmcnt(12)
    ds_read_b32 v8, v18
    v_mfma_f32_32x32x16_bf16 v[96:111], v[48:51], v[160:163], v[96:111]
    v_mfma_f32_32x32x16_bf16 v[112:127], v[48:51], v[164:167], v[112:127]
    buffer_load_dwordx4 v[48:51], v11, s[64:67], s54 offen offset:1024 sc1
    s_waitcnt vmcnt(17)
    v_mfma_f32_32x32x16_bf16 v[128:143], v[52:55], v[160:163], v[128:143]
    v_mfma_f32_32x32x16_bf16 v[144:159], v[52:55], v[164:167], v[144:159]
    buffer_load_dwordx4 v[52:55], v11, s[64:67], s53 offen offset:1024 sc1
    s_mov_b32 s73, 0
L_c_r16:
    s_waitcnt lgkmcnt(0)
    v_readfirstlane_b32 s11, v8
    s_nop 0
    s_cmp_ge_u32 s11, 2
    s_cbranch_scc1 L_c_r16ok
    s_add_u32 s73, s73, 1
    s_cmp_ge_u32 s73, 1048576
    s_cbranch_scc1 L_c_r16ok
    s_sleep 1
    ds_read_b32 v8, v18 offset:0
    s_branch L_c_r16
L_c_r16ok:
    s_mov_b64 exec, 1
    ds_add_u32 v17, v10 offset:4
    s_mov_b64 exec, -1
    ds_read_b64_tr_b16 v[192:193], v3 offset:0
    ds_read_b64_tr_b16 v[194:195], v3 offset:1024
    ds_read_b64_tr_b16 v[196:197], v4 offset:0
    ds_read_b64_tr_b16 v[198:199], v4 offset:1024
    s_waitcnt vmcnt(17)
    v_mfma_f32_32x32x16_bf16 v[96:111], v[56:59], v[168:171], v[96:111]
    v_mfma_f32_32x32x16_bf16 v[112:127], v[56:59], v[172:175], v[112:127]
    buffer_load_dwordx4 v[56:59], v11, s[64:67], s54 offen offset:2048 sc1
    s_waitcnt vmcnt(17)
    v_mfma_f32_32x32x16_bf16 v[128:143], v[60:63], v[168:171], v[128:143]
    v_mfma_f32_32x32x16_bf16 v[144:159], v[60:63], v[172:175], v[144:159]
    buffer_load_dwordx4 v[60:63], v11, s[64:67], s53 offen offset:2048 sc1
    ds_read_b64_tr_b16 v[200:201], v3 offset:2048
    ds_read_b64_tr_b16 v[202:203], v3 offset:3072
    ds_read_b64_tr_b16 v[204:205], v4 offset:2048
    ds_read_b64_tr_b16 v[206:207], v4 offset:3072
    s_waitcnt vmcnt(17)
    v_mfma_f32_32x32x16_bf16 v[96:111], v[64:67], v[176:179], v[96:111]
    v_mfma_f32_32x32x16_bf16 v[112:127], v[64:67], v[180:183], v[112:127]
    buffer_load_dwordx4 v[64:67], v11, s[64:67], s54 offen offset:3072 sc1
    s_waitcnt vmcnt(17)
    v_mfma_f32_32x32x16_bf16 v[128:143], v[68:71], v[176:179], v[128:143]
    v_mfma_f32_32x32x16_bf16 v[144:159], v[68:71], v[180:183], v[144:159]
    buffer_load_dwordx4 v[68:71], v11, s[64:67], s53 offen offset:3072 sc1
    ds_read_b64_tr_b16 v[208:209], v3 offset:4096
    ds_read_b64_tr_b16 v[210:211], v3 offset:5120
    ds_read_b64_tr_b16 v[212:213], v4 offset:4096
    ds_read_b64_tr_b16 v[214:215], v4 offset:5120
    s_waitcnt vmcnt(17)
    v_mfma_f32_32x32x16_bf16 v[96:111], v[72:75], v[184:187], v[96:111]
    v_mfma_f32_32x32x16_bf16 v[112:127], v[72:75], v[188:191], v[112:127]
    s_lshl_b32 s11, s60, 12
    s_add_u32 s54, s11, s52
    s_add_u32 s53, s11, s51
    s_add_u32 s60, s60, 1
    s_cmp_eq_u32 s60, 7
    s_cselect_b32 s60, 0, s60
    buffer_load_dwordx4 v[72:75], v11, s[64:67], s54 offen offset:0 sc1
    s_waitcnt vmcnt(17)
    v_mfma_f32_32x32x16_bf16 v[128:143], v[76:79], v[184:187], v[128:143]
    v_mfma_f32_32x32x16_bf16 v[144:159], v[76:79], v[188:191], v[144:159]
    buffer_load_dwordx4 v[76:79], v11, s[64:67], s53 offen offset:0 sc1
    ds_read_b64_tr_b16 v[216:217], v3 offset:6144
    ds_read_b64_tr_b16 v[218:219], v3 offset:7168
    ds_read_b64_tr_b16 v[220:221], v4 offset:6144
    ds_read_b64_tr_b16 v[222:223], v4 offset:7168
    s_waitcnt vmcnt(17) lgkmcnt(12)
    v_mfma_f32_32x32x16_bf16 v[96:111], v[80:83], v[192:195], v[96:111]
    v_mfma_f32_32x32x16_bf16 v[112:127], v[80:83], v[196:199], v[112:127]
    buffer_load_dwordx4 v[80:83], v11, s[64:67], s54 offen offset:1024 sc1
    s_waitcnt vmcnt(17)
    v_mfma_f32_32x32x16_bf16 v[128:143], v[84:87], v[192:195], v[128:143]
    v_mfma_f32_32x32x16_bf16 v[144:159], v[84:87], v[196:199], v[144:159]
    buffer_load_dwordx4 v[84:87], v11, s[64:67], s53 offen offset:1024 sc1
    ds_read_b64_tr_b16 v[224:225], v5 offset:0
    ds_read_b64_tr_b16 v[226:227], v5 offset:1024
    ds_read_b64_tr_b16 v[228:229], v6 offset:0
    ds_read_b64_tr_b16 v[230:231], v6 offset:1024
    s_waitcnt vmcnt(17) lgkmcnt(12)
    v_mfma_f32_32x32x16_bf16 v[96:111], v[88:91], v[200:203], v[96:111]
    v_mfma_f32_32x32x16_bf16 v[112:127], v[88:91], v[204:207], v[112:127]
    buffer_load_dwordx4 v[88:91], v11, s[64:67], s54 offen offset:2048 sc1
    s_waitcnt vmcnt(17)
    v_mfma_f32_32x32x16_bf16 v[128:143], v[92:95], v[200:203], v[128:143]
    v_mfma_f32_32x32x16_bf16 v[144:159], v[92:95], v[204:207], v[144:159]
    buffer_load_dwordx4 v[92:95], v11, s[64:67], s53 offen offset:2048 sc1
    ds_read_b64_tr_b16 v[232:233], v5 offset:2048
    ds_read_b64_tr_b16 v[234:235], v5 offset:3072
    ds_read_b64_tr_b16 v[236:237], v6 offset:2048
    ds_read_b64_tr_b16 v[238:239], v6 offset:3072
    s_waitcnt vmcnt(17) lgkmcnt(12)
    ds_read_b32 v8, v18
    v_mfma_f32_32x32x16_bf16 v[96:111], v[24:27], v[208:211], v[96:111]
    v_mfma_f32_32x32x16_bf16 v[112:127], v[24:27], v[212:215], v[112:127]
    buffer_load_dwordx4 v[24:27], v11, s[64:67], s54 offen offset:3072 sc1
    s_waitcnt vmcnt(17)
    v_mfma_f32_32x32x16_bf16 v[128:143], v[28:31], v[208:211], v[128:143]
    v_mfma_f32_32x32x16_bf16 v[144:159], v[28:31], v[212:215], v[144:159]
    buffer_load_dwordx4 v[28:31], v11, s[64:67], s53 offen offset:3072 sc1
    s_mov_b32 s73, 0
L_c_r22:
    s_waitcnt lgkmcnt(0)
    v_readfirstlane_b32 s11, v8
    s_nop 0
    s_cmp_ge_u32 s11, 3
    s_cbranch_scc1 L_c_r22ok
    s_add_u32 s73, s73, 1
    s_cmp_ge_u32 s73, 1048576
    s_cbranch_scc1 L_c_r22ok
    s_sleep 1
    ds_read_b32 v8, v18 offset:0
    s_branch L_c_r22
L_c_r22ok:
    ds_read_b64_tr_b16 v[240:241], v5 offset:4096
    ds_read_b64_tr_b16 v[242:243], v5 offset:5120
    ds_read_b64_tr_b16 v[244:245], v6 offset:4096
    ds_read_b64_tr_b16 v[246:247], v6 offset:5120
    s_waitcnt vmcnt(17)
    v_mfma_f32_32x32x16_bf16 v[96:111], v[32:35], v[216:219], v[96:111]
    v_mfma_f32_32x32x16_bf16 v[112:127], v[32:35], v[220:223], v[112:127]
    s_waitcnt vmcnt(16)
    v_mfma_f32_32x32x16_bf16 v[128:143], v[36:39], v[216:219], v[128:143]
    v_mfma_f32_32x32x16_bf16 v[144:159], v[36:39], v[220:223], v[144:159]
    ds_read_b64_tr_b16 v[248:249], v5 offset:6144
    ds_read_b64_tr_b16 v[250:251], v5 offset:7168
    ds_read_b64_tr_b16 v[252:253], v6 offset:6144
    ds_read_b64_tr_b16 v[254:255], v6 offset:7168
    s_waitcnt vmcnt(15)
    v_mfma_f32_32x32x16_bf16 v[112:127], v[40:43], v[228:231], v[112:127]
    s_waitcnt vmcnt(14)
    v_mfma_f32_32x32x16_bf16 v[128:143], v[44:47], v[224:227], v[128:143]
    v_mfma_f32_32x32x16_bf16 v[144:159], v[44:47], v[228:231], v[144:159]
    ds_read_b64_tr_b16 v[160:161], v3 offset:8192
    ds_read_b64_tr_b16 v[162:163], v3 offset:9216
    ds_read_b64_tr_b16 v[164:165], v4 offset:8192
    ds_read_b64_tr_b16 v[166:167], v4 offset:9216
    s_waitcnt vmcnt(13)
    v_mfma_f32_32x32x16_bf16 v[112:127], v[48:51], v[236:239], v[112:127]
    s_waitcnt vmcnt(12)
    v_mfma_f32_32x32x16_bf16 v[128:143], v[52:55], v[232:235], v[128:143]
    v_mfma_f32_32x32x16_bf16 v[144:159], v[52:55], v[236:239], v[144:159]
    ds_read_b64_tr_b16 v[168:169], v3 offset:10240
    ds_read_b64_tr_b16 v[170:171], v3 offset:11264
    ds_read_b64_tr_b16 v[172:173], v4 offset:10240
    ds_read_b64_tr_b16 v[174:175], v4 offset:11264
    s_waitcnt vmcnt(11) lgkmcnt(12)
    v_mfma_f32_32x32x16_bf16 v[112:127], v[56:59], v[244:247], v[112:127]
    s_waitcnt vmcnt(10)
    v_mfma_f32_32x32x16_bf16 v[128:143], v[60:63], v[240:243], v[128:143]
    v_mfma_f32_32x32x16_bf16 v[144:159], v[60:63], v[244:247], v[144:159]
    ds_read_b64_tr_b16 v[176:177], v5 offset:8192
    ds_read_b64_tr_b16 v[178:179], v5 offset:9216
    ds_read_b64_tr_b16 v[180:181], v6 offset:8192
    ds_read_b64_tr_b16 v[182:183], v6 offset:9216
    s_waitcnt vmcnt(9) lgkmcnt(12)
    v_mfma_f32_32x32x16_bf16 v[112:127], v[64:67], v[252:255], v[112:127]
    s_waitcnt vmcnt(8)
    v_mfma_f32_32x32x16_bf16 v[128:143], v[68:71], v[248:251], v[128:143]
    v_mfma_f32_32x32x16_bf16 v[144:159], v[68:71], v[252:255], v[144:159]
    ds_read_b64_tr_b16 v[184:185], v5 offset:10240
    ds_read_b64_tr_b16 v[186:187], v5 offset:11264
    ds_read_b64_tr_b16 v[188:189], v6 offset:10240
    ds_read_b64_tr_b16 v[190:191], v6 offset:11264
    s_waitcnt vmcnt(7) lgkmcnt(12)
    v_mfma_f32_32x32x16_bf16 v[112:127], v[72:75], v[164:167], v[112:127]
    s_waitcnt vmcnt(6)
    v_mfma_f32_32x32x16_bf16 v[128:143], v[76:79], v[160:163], v[128:143]
    v_mfma_f32_32x32x16_bf16 v[144:159], v[76:79], v[164:167], v[144:159]
    ds_read_b128 v[192:195], v16 offset:0
    ds_read_b128 v[196:199], v16 offset:16
    ds_read_b128 v[200:203], v16 offset:32
    ds_read_b128 v[204:207], v16 offset:48
    ds_read_b128 v[208:211], v16 offset:64
    ds_read_b128 v[212:215], v16 offset:80
    ds_read_b128 v[216:219], v16 offset:96
    ds_read_b128 v[220:223], v16 offset:112
    s_waitcnt vmcnt(5) lgkmcnt(12)
    v_mfma_f32_32x32x16_bf16 v[112:127], v[80:83], v[172:175], v[112:127]
    s_waitcnt vmcnt(4)
    v_mfma_f32_32x32x16_bf16 v[128:143], v[84:87], v[168:171], v[128:143]
    v_mfma_f32_32x32x16_bf16 v[144:159], v[84:87], v[172:175], v[144:159]
    s_waitcnt vmcnt(3)
    v_mfma_f32_32x32x16_bf16 v[112:127], v[88:91], v[180:183], v[112:127]
    s_waitcnt vmcnt(2)
    v_mfma_f32_32x32x16_bf16 v[128:143], v[92:95], v[176:179], v[128:143]
    v_mfma_f32_32x32x16_bf16 v[144:159], v[92:95], v[180:183], v[144:159]
    s_xor_b32 s11, s10, 1
    s_mul_i32 s11, s11, 12288
    s_add_u32 s11, s11, 53248
    v_add_u32 v1, s11, v11
    s_xor_b32 s11, s10, 2
    s_mul_i32 s11, s11, 12288
    s_add_u32 s11, s11, 57344
    v_add_u32 v2, s11, v11
    s_xor_b32 s11, s10, 3
    s_mul_i32 s11, s11, 12288
    s_add_u32 s11, s11, 61440
    v_add_u32 v3, s11, v11
    v_add_u32 v4, 106496, v15
    v_add_u32 v5, 53248, v15
    s_waitcnt vmcnt(1) lgkmcnt(8)
    v_mfma_f32_32x32x16_bf16 v[112:127], v[24:27], v[188:191], v[112:127]
    s_waitcnt vmcnt(0)
    v_mfma_f32_32x32x16_bf16 v[128:143], v[28:31], v[184:187], v[128:143]
    v_mfma_f32_32x32x16_bf16 v[144:159], v[28:31], v[188:191], v[144:159]
    v_mfma_f32_32x32x16_bf16 v[96:111], v[40:43], v[224:227], v[96:111]
    s_nop 7
    ds_write_b128 v5, v[112:115] offset:4096
    v_mfma_f32_32x32x16_bf16 v[96:111], v[48:51], v[232:235], v[96:111]
    ds_write_b128 v5, v[116:119] offset:5120
    v_mfma_f32_32x32x16_bf16 v[96:111], v[56:59], v[240:243], v[96:111]
    ds_write_b128 v5, v[120:123] offset:6144
    v_mfma_f32_32x32x16_bf16 v[96:111], v[64:67], v[248:251], v[96:111]
    ds_write_b128 v5, v[124:127] offset:7168
    v_mfma_f32_32x32x16_bf16 v[96:111], v[72:75], v[160:163], v[96:111]
    ds_write_b128 v5, v[128:131] offset:0
    v_mfma_f32_32x32x16_bf16 v[96:111], v[80:83], v[168:171], v[96:111]
    ds_write_b128 v5, v[132:135] offset:1024
    v_mfma_f32_32x32x16_bf16 v[96:111], v[88:91], v[176:179], v[96:111]
    ds_write_b128 v5, v[136:139] offset:2048
    v_mfma_f32_32x32x16_bf16 v[96:111], v[24:27], v[184:187], v[96:111]
    ds_write_b128 v5, v[140:143] offset:3072
    ds_write_b128 v5, v[144:147] offset:8192
    ds_write_b128 v5, v[148:151] offset:9216
    ds_write_b128 v5, v[152:155] offset:10240
    ds_write_b128 v5, v[156:159] offset:11264
    s_waitcnt lgkmcnt(12)
    v_mul_f32 v192, v193, v193
    v_mul_f32 v194, v195, v195
    v_mul_f32 v196, v197, v197
    v_mul_f32 v198, v199, v199
    v_mul_f32 v200, v201, v201
    v_mul_f32 v202, v203, v203
    v_mul_f32 v204, v205, v205
    v_mul_f32 v206, v207, v207
    v_mul_f32 v208, v209, v209
    v_mul_f32 v210, v211, v211
    v_mul_f32 v212, v213, v213
    v_mul_f32 v214, v215, v215
    v_mul_f32 v216, v217, v217
    v_mul_f32 v218, v219, v219
    v_mul_f32 v220, v221, v221
    v_mul_f32 v222, v223, v223
    s_mov_b32 s13, 0xbfb8aa3b
    s_waitcnt lgkmcnt(0)
    s_mov_b64 exec, 1
    ds_add_u32 v17, v10
    s_mov_b64 exec, -1
    ds_read_b32 v8, v17
    s_mov_b32 s73, 0
L_c_cnt:
    s_waitcnt lgkmcnt(0)
    v_readfirstlane_b32 s11, v8
    s_nop 0
    s_cmp_ge_u32 s11, 4
    s_cbranch_scc1 L_c_cntok
    s_add_u32 s73, s73, 1
    s_cmp_ge_u32 s73, 1048576
    s_cbranch_scc1 L_c_cntok
    s_sleep 1
    ds_read_b32 v8, v17 offset:0
    s_branch L_c_cnt
L_c_cntok:
    ds_read_b128 v[24:27], v1 offset:0
    ds_read_b128 v[40:43], v2 offset:0
    ds_read_b128 v[56:59], v3 offset:0
    ds_read_b128 v[28:31], v1 offset:1024
    ds_read_b128 v[44:47], v2 offset:1024
    ds_read_b128 v[60:63], v3 offset:1024
    ds_read_b128 v[32:35], v1 offset:2048
    ds_read_b128 v[48:51], v2 offset:2048
    ds_read_b128 v[64:67], v3 offset:2048
    ds_read_b128 v[36:39], v1 offset:3072
    ds_read_b128 v[52:55], v2 offset:3072
    ds_read_b128 v[68:71], v3 offset:3072
    s_waitcnt lgkmcnt(9)
    v_add_f32 v96, v96, v24
    v_add_f32 v97, v97, v25
    v_add_f32 v98, v98, v26
    v_add_f32 v99, v99, v27
    v_add_f32 v40, v40, v56
    v_add_f32 v41, v41, v57
    v_add_f32 v42, v42, v58
    v_add_f32 v43, v43, v59
    v_add_f32 v96, v96, v40
    v_add_f32 v97, v97, v41
    v_add_f32 v98, v98, v42
    v_add_f32 v99, v99, v43
    v_mul_f32 v96, v96, v192
    v_mul_f32 v97, v97, v194
    v_mul_f32 v98, v98, v196
    v_mul_f32 v99, v99, v198
    v_mul_f32 v72, s13, v96
    v_mul_f32 v73, s13, v97
    v_mul_f32 v74, s13, v98
    v_mul_f32 v75, s13, v99
    v_exp_f32 v72, v72
    v_exp_f32 v73, v73
    v_exp_f32 v74, v74
    v_exp_f32 v75, v75
    s_waitcnt lgkmcnt(6)
    v_add_f32 v100, v100, v28
    v_add_f32 v101, v101, v29
    v_add_f32 v102, v102, v30
    v_add_f32 v103, v103, v31
    v_add_f32 v44, v44, v60
    v_add_f32 v45, v45, v61
    v_add_f32 v46, v46, v62
    v_add_f32 v47, v47, v63
    v_add_f32 v100, v100, v44
    v_add_f32 v101, v101, v45
    v_add_f32 v102, v102, v46
    v_add_f32 v103, v103, v47
    v_mul_f32 v100, v100, v200
    v_mul_f32 v101, v101, v202
    v_mul_f32 v102, v102, v204
    v_mul_f32 v103, v103, v206
    v_mul_f32 v76, s13, v100
    v_mul_f32 v77, s13, v101
    v_mul_f32 v78, s13, v102
    v_mul_f32 v79, s13, v103
    v_exp_f32 v76, v76
    v_exp_f32 v77, v77
    v_exp_f32 v78, v78
    v_exp_f32 v79, v79
    s_waitcnt lgkmcnt(3)
    v_add_f32 v104, v104, v32
    v_add_f32 v105, v105, v33
    v_add_f32 v106, v106, v34
    v_add_f32 v107, v107, v35
    v_add_f32 v48, v48, v64
    v_add_f32 v49, v49, v65
    v_add_f32 v50, v50, v66
    v_add_f32 v51, v51, v67
    v_add_f32 v104, v104, v48
    v_add_f32 v105, v105, v49
    v_add_f32 v106, v106, v50
    v_add_f32 v107, v107, v51
    v_mul_f32 v104, v104, v208
    v_mul_f32 v105, v105, v210
    v_mul_f32 v106, v106, v212
    v_mul_f32 v107, v107, v214
    v_mul_f32 v80, s13, v104
    v_mul_f32 v81, s13, v105
    v_mul_f32 v82, s13, v106
    v_mul_f32 v83, s13, v107
    v_exp_f32 v80, v80
    v_exp_f32 v81, v81
    v_exp_f32 v82, v82
    v_exp_f32 v83, v83
    s_waitcnt lgkmcnt(0)
    v_add_f32 v108, v108, v36
    v_add_f32 v109, v109, v37
    v_add_f32 v110, v110, v38
    v_add_f32 v111, v111, v39
    v_add_f32 v52, v52, v68
    v_add_f32 v53, v53, v69
    v_add_f32 v54, v54, v70
    v_add_f32 v55, v55, v71
    v_add_f32 v108, v108, v52
    v_add_f32 v109, v109, v53
    v_add_f32 v110, v110, v54
    v_add_f32 v111, v111, v55
    v_mul_f32 v108, v108, v216
    v_mul_f32 v109, v109, v218
    v_mul_f32 v110, v110, v220
    v_mul_f32 v111, v111, v222
    v_mul_f32 v84, s13, v108
    v_mul_f32 v85, s13, v109
    v_mul_f32 v86, s13, v110
    v_mul_f32 v87, s13, v111
    v_exp_f32 v84, v84
    v_exp_f32 v85, v85
    v_exp_f32 v86, v86
    v_exp_f32 v87, v87
    v_add_f32 v72, 1.0, v72
    v_add_f32 v73, 1.0, v73
    v_add_f32 v74, 1.0, v74
    v_add_f32 v75, 1.0, v75
    v_rcp_f32 v72, v72
    v_rcp_f32 v73, v73
    v_rcp_f32 v74, v74
    v_rcp_f32 v75, v75
    v_mul_f32 v96, v96, v72
    v_mul_f32 v97, v97, v73
    v_mul_f32 v98, v98, v74
    v_mul_f32 v99, v99, v75
    ds_write_b128 v4, v[96:99] offset:0
    v_add_f32 v76, 1.0, v76
    v_add_f32 v77, 1.0, v77
    v_add_f32 v78, 1.0, v78
    v_add_f32 v79, 1.0, v79
    v_rcp_f32 v76, v76
    v_rcp_f32 v77, v77
    v_rcp_f32 v78, v78
    v_rcp_f32 v79, v79
    v_mul_f32 v100, v100, v76
    v_mul_f32 v101, v101, v77
    v_mul_f32 v102, v102, v78
    v_mul_f32 v103, v103, v79
    ds_write_b128 v4, v[100:103] offset:1024
    v_add_f32 v80, 1.0, v80
    v_add_f32 v81, 1.0, v81
    v_add_f32 v82, 1.0, v82
    v_add_f32 v83, 1.0, v83
    v_rcp_f32 v80, v80
    v_rcp_f32 v81, v81
    v_rcp_f32 v82, v82
    v_rcp_f32 v83, v83
    v_mul_f32 v104, v104, v80
    v_mul_f32 v105, v105, v81
    v_mul_f32 v106, v106, v82
    v_mul_f32 v107, v107, v83
    ds_write_b128 v4, v[104:107] offset:2048
    v_add_f32 v84, 1.0, v84
    v_add_f32 v85, 1.0, v85
    v_add_f32 v86, 1.0, v86
    v_add_f32 v87, 1.0, v87
    v_rcp_f32 v84, v84
    v_rcp_f32 v85, v85
    v_rcp_f32 v86, v86
    v_rcp_f32 v87, v87
    v_mul_f32 v108, v108, v84
    v_mul_f32 v109, v109, v85
    v_mul_f32 v110, v110, v86
    v_mul_f32 v111, v111, v87
    ds_write_b128 v4, v[108:111] offset:3072
    s_waitcnt lgkmcnt(0)
    s_barrier
    s_endpgm
.p2align 12
L_helper:
    s_sub_u32 s73, s5, 28
    s_lshl_b32 s11, s73, 3
    s_add_u32 s72, s11, s4
    s_mov_b32 s72, s8
    v_mov_b32 v200, 65536
    v_mov_b32 v201, 0
    ds_write_b32 v200, v201
    s_cmp_ge_u32 s3, 4
    s_cbranch_scc1 L_h_pf
    s_lshl_b32 s11, s72, 6
    s_lshl_b32 s12, s3, 4
    s_add_u32 s11, s11, s12
    v_lshrrev_b32 v2, 3, v0
    v_add_u32 v2, s11, v2
    v_mul_u32_u24 v3, 896, v2
    v_and_b32 v4, 7, v0
    v_lshl_add_u32 v3, v4, 4, v3
    s_waitcnt lgkmcnt(0)
    s_mov_b32 s48, s16
    s_and_b32 s49, s17, 0xffff
    s_mov_b32 s50, 0x1c0000
    s_mov_b32 s51, 0x20000
    s_mov_b32 s64, s46
    s_and_b32 s65, s47, 0xffff
    s_mov_b32 s66, 0x1000000
    s_mov_b32 s67, 0x20000
    s_mov_b32 s11, 7168
    buffer_load_dwordx4 v[112:115], v3, s[48:51], 0 offen offset:0
    buffer_load_dwordx4 v[116:119], v3, s[48:51], 0 offen offset:128
    buffer_load_dwordx4 v[120:123], v3, s[48:51], 0 offen offset:256
    buffer_load_dwordx4 v[124:127], v3, s[48:51], 0 offen offset:384
    buffer_load_dwordx4 v[128:131], v3, s[48:51], 0 offen offset:512
    buffer_load_dwordx4 v[132:135], v3, s[48:51], 0 offen offset:640
    buffer_load_dwordx4 v[136:139], v3, s[48:51], 0 offen offset:768
    buffer_load_dwordx4 v[140:143], v3, s[48:51], s11 offen offset:0
    buffer_load_dwordx4 v[144:147], v3, s[48:51], s11 offen offset:128
    buffer_load_dwordx4 v[148:151], v3, s[48:51], s11 offen offset:256
    buffer_load_dwordx4 v[152:155], v3, s[48:51], s11 offen offset:384
    buffer_load_dwordx4 v[156:159], v3, s[48:51], s11 offen offset:512
    buffer_load_dwordx4 v[160:163], v3, s[48:51], s11 offen offset:640
    buffer_load_dwordx4 v[164:167], v3, s[48:51], s11 offen offset:768
    s_cmp_gt_u32 s3, 1
    s_cbranch_scc1 L_h_noreset
    s_cmp_eq_u32 s3, 0
    s_cselect_b32 s11, -1, 0
    s_mov_b32 s12, 1024
    s_cmov_b32 s12, 896
    s_mov_b32 s13, 0xb0c000
    s_cmov_b32 s13, 0xb04000
    s_mul_i32 s14, s12, s72
    s_add_u32 s13, s13, s14
    v_mov_b32 v8, s11
    v_mov_b32 v9, s11
    v_mov_b32 v10, s11
    v_mov_b32 v11, s11
    v_lshlrev_b32 v12, 4, v0
    v_cmp_gt_u32 vcc, s12, v12
    s_nop 0
    s_and_saveexec_b64 s[14:15], vcc
    buffer_store_dwordx4 v[8:11], v12, s[64:67], s13 offen sc1
    s_mov_b64 exec, s[14:15]
L_h_noreset:
    s_waitcnt lgkmcnt(0)
    s_barrier
    v_lshlrev_b32 v2, 3, v2
    s_mov_b32 s12, 0xffff0000
    s_waitcnt vmcnt(7)
    v_lshlrev_b32 v48, 16, v112
    v_and_b32 v49, s12, v112
    v_lshlrev_b32 v50, 16, v113
    v_and_b32 v51, s12, v113
    v_lshlrev_b32 v52, 16, v114
    v_and_b32 v53, s12, v114
    v_lshlrev_b32 v54, 16, v115
    v_and_b32 v55, s12, v115
    v_lshlrev_b32 v56, 16, v116
    v_and_b32 v57, s12, v116
    v_lshlrev_b32 v58, 16, v117
    v_and_b32 v59, s12, v117
    v_lshlrev_b32 v60, 16, v118
    v_and_b32 v61, s12, v118
    v_lshlrev_b32 v62, 16, v119
    v_and_b32 v63, s12, v119
    v_lshlrev_b32 v64, 16, v120
    v_and_b32 v65, s12, v120
    v_lshlrev_b32 v66, 16, v121
    v_and_b32 v67, s12, v121
    v_lshlrev_b32 v68, 16, v122
    v_and_b32 v69, s12, v122
    v_lshlrev_b32 v70, 16, v123
    v_and_b32 v71, s12, v123
    v_lshlrev_b32 v72, 16, v124
    v_and_b32 v73, s12, v124
    v_lshlrev_b32 v74, 16, v125
    v_and_b32 v75, s12, v125
    v_lshlrev_b32 v76, 16, v126
    v_and_b32 v77, s12, v126
    v_lshlrev_b32 v78, 16, v127
    v_and_b32 v79, s12, v127
    v_lshlrev_b32 v80, 16, v128
    v_and_b32 v81, s12, v128
    v_lshlrev_b32 v82, 16, v129
    v_and_b32 v83, s12, v129
    v_lshlrev_b32 v84, 16, v130
    v_and_b32 v85, s12, v130
    v_lshlrev_b32 v86, 16, v131
    v_and_b32 v87, s12, v131
    v_lshlrev_b32 v88, 16, v132
    v_and_b32 v89, s12, v132
    v_lshlrev_b32 v90, 16, v133
    v_and_b32 v91, s12, v133
    v_lshlrev_b32 v92, 16, v134
    v_and_b32 v93, s12, v134
    v_lshlrev_b32 v94, 16, v135
    v_and_b32 v95, s12, v135
    v_lshlrev_b32 v96, 16, v136
    v_and_b32 v97, s12, v136
    v_lshlrev_b32 v98, 16, v137
    v_and_b32 v99, s12, v137
    v_lshlrev_b32 v100, 16, v138
    v_and_b32 v101, s12, v138
    v_lshlrev_b32 v102, 16, v139
    v_and_b32 v103, s12, v139
    v_pk_add_f32 v[8:9], v[48:49], v[52:53]
    v_pk_add_f32 v[10:11], v[50:51], v[54:55]
    v_pk_add_f32 v[8:9], v[8:9], v[56:57]
    v_pk_add_f32 v[10:11], v[10:11], v[58:59]
    v_pk_add_f32 v[8:9], v[8:9], v[60:61]
    v_pk_add_f32 v[10:11], v[10:11], v[62:63]
    v_pk_add_f32 v[8:9], v[8:9], v[64:65]
    v_pk_add_f32 v[10:11], v[10:11], v[66:67]
    v_pk_add_f32 v[8:9], v[8:9], v[68:69]
    v_pk_add_f32 v[10:11], v[10:11], v[70:71]
    v_pk_add_f32 v[8:9], v[8:9], v[72:73]
    v_pk_add_f32 v[10:11], v[10:11], v[74:75]
    v_pk_add_f32 v[8:9], v[8:9], v[76:77]
    v_pk_add_f32 v[10:11], v[10:11], v[78:79]
    v_pk_add_f32 v[8:9], v[8:9], v[80:81]
    v_pk_add_f32 v[10:11], v[10:11], v[82:83]
    v_pk_add_f32 v[8:9], v[8:9], v[84:85]
    v_pk_add_f32 v[10:11], v[10:11], v[86:87]
    v_pk_add_f32 v[8:9], v[8:9], v[88:89]
    v_pk_add_f32 v[10:11], v[10:11], v[90:91]
    v_pk_add_f32 v[8:9], v[8:9], v[92:93]
    v_pk_add_f32 v[10:11], v[10:11], v[94:95]
    v_pk_add_f32 v[8:9], v[8:9], v[96:97]
    v_pk_add_f32 v[10:11], v[10:11], v[98:99]
    v_pk_add_f32 v[8:9], v[8:9], v[100:101]
    v_pk_add_f32 v[10:11], v[10:11], v[102:103]
    v_add_f32 v8, v8, v9
    v_add_f32 v10, v10, v11
    v_add_f32 v12, v8, v10
    s_nop 1
    v_add_f32_dpp v12, v12, v12 quad_perm:[1,0,3,2] row_mask:0xf bank_mask:0xf
    s_nop 1
    v_add_f32_dpp v12, v12, v12 quad_perm:[2,3,0,1] row_mask:0xf bank_mask:0xf
    s_nop 1
    v_add_f32_dpp v12, v12, v12 row_half_mirror row_mask:0xf bank_mask:0xf
    v_mul_f32 v12, 0x3b124925, v12
    v_pk_add_f32 v[48:49], v[48:49], v[12:13] op_sel_hi:[1,0] neg_lo:[0,1] neg_hi:[0,1]
    v_pk_add_f32 v[50:51], v[50:51], v[12:13] op_sel_hi:[1,0] neg_lo:[0,1] neg_hi:[0,1]
    v_pk_add_f32 v[52:53], v[52:53], v[12:13] op_sel_hi:[1,0] neg_lo:[0,1] neg_hi:[0,1]
    v_pk_add_f32 v[54:55], v[54:55], v[12:13] op_sel_hi:[1,0] neg_lo:[0,1] neg_hi:[0,1]
    v_pk_add_f32 v[56:57], v[56:57], v[12:13] op_sel_hi:[1,0] neg_lo:[0,1] neg_hi:[0,1]
    v_pk_add_f32 v[58:59], v[58:59], v[12:13] op_sel_hi:[1,0] neg_lo:[0,1] neg_hi:[0,1]
    v_pk_add_f32 v[60:61], v[60:61], v[12:13] op_sel_hi:[1,0] neg_lo:[0,1] neg_hi:[0,1]
    v_pk_add_f32 v[62:63], v[62:63], v[12:13] op_sel_hi:[1,0] neg_lo:[0,1] neg_hi:[0,1]
    v_pk_add_f32 v[64:65], v[64:65], v[12:13] op_sel_hi:[1,0] neg_lo:[0,1] neg_hi:[0,1]
    v_pk_add_f32 v[66:67], v[66:67], v[12:13] op_sel_hi:[1,0] neg_lo:[0,1] neg_hi:[0,1]
    v_pk_add_f32 v[68:69], v[68:69], v[12:13] op_sel_hi:[1,0] neg_lo:[0,1] neg_hi:[0,1]
    v_pk_add_f32 v[70:71], v[70:71], v[12:13] op_sel_hi:[1,0] neg_lo:[0,1] neg_hi:[0,1]
    v_pk_add_f32 v[72:73], v[72:73], v[12:13] op_sel_hi:[1,0] neg_lo:[0,1] neg_hi:[0,1]
    v_pk_add_f32 v[74:75], v[74:75], v[12:13] op_sel_hi:[1,0] neg_lo:[0,1] neg_hi:[0,1]
    v_pk_add_f32 v[76:77], v[76:77], v[12:13] op_sel_hi:[1,0] neg_lo:[0,1] neg_hi:[0,1]
    v_pk_add_f32 v[78:79], v[78:79], v[12:13] op_sel_hi:[1,0] neg_lo:[0,1] neg_hi:[0,1]
    v_pk_add_f32 v[80:81], v[80:81], v[12:13] op_sel_hi:[1,0] neg_lo:[0,1] neg_hi:[0,1]
    v_pk_add_f32 v[82:83], v[82:83], v[12:13] op_sel_hi:[1,0] neg_lo:[0,1] neg_hi:[0,1]
    v_pk_add_f32 v[84:85], v[84:85], v[12:13] op_sel_hi:[1,0] neg_lo:[0,1] neg_hi:[0,1]
    v_pk_add_f32 v[86:87], v[86:87], v[12:13] op_sel_hi:[1,0] neg_lo:[0,1] neg_hi:[0,1]
    v_pk_add_f32 v[88:89], v[88:89], v[12:13] op_sel_hi:[1,0] neg_lo:[0,1] neg_hi:[0,1]
    v_pk_add_f32 v[90:91], v[90:91], v[12:13] op_sel_hi:[1,0] neg_lo:[0,1] neg_hi:[0,1]
    v_pk_add_f32 v[92:93], v[92:93], v[12:13] op_sel_hi:[1,0] neg_lo:[0,1] neg_hi:[0,1]
    v_pk_add_f32 v[94:95], v[94:95], v[12:13] op_sel_hi:[1,0] neg_lo:[0,1] neg_hi:[0,1]
    v_pk_add_f32 v[96:97], v[96:97], v[12:13] op_sel_hi:[1,0] neg_lo:[0,1] neg_hi:[0,1]
    v_pk_add_f32 v[98:99], v[98:99], v[12:13] op_sel_hi:[1,0] neg_lo:[0,1] neg_hi:[0,1]
    v_pk_add_f32 v[100:101], v[100:101], v[12:13] op_sel_hi:[1,0] neg_lo:[0,1] neg_hi:[0,1]
    v_pk_add_f32 v[102:103], v[102:103], v[12:13] op_sel_hi:[1,0] neg_lo:[0,1] neg_hi:[0,1]
    v_pk_mul_f32 v[8:9], v[48:49], v[48:49]
    v_pk_mul_f32 v[10:11], v[50:51], v[50:51]
    v_pk_fma_f32 v[8:9], v[52:53], v[52:53], v[8:9]
    v_pk_fma_f32 v[10:11], v[54:55], v[54:55], v[10:11]
    v_pk_fma_f32 v[8:9], v[56:57], v[56:57], v[8:9]
    v_pk_fma_f32 v[10:11], v[58:59], v[58:59], v[10:11]
    v_pk_fma_f32 v[8:9], v[60:61], v[60:61], v[8:9]
    v_pk_fma_f32 v[10:11], v[62:63], v[62:63], v[10:11]
    v_pk_fma_f32 v[8:9], v[64:65], v[64:65], v[8:9]
    v_pk_fma_f32 v[10:11], v[66:67], v[66:67], v[10:11]
    v_pk_fma_f32 v[8:9], v[68:69], v[68:69], v[8:9]
    v_pk_fma_f32 v[10:11], v[70:71], v[70:71], v[10:11]
    v_pk_fma_f32 v[8:9], v[72:73], v[72:73], v[8:9]
    v_pk_fma_f32 v[10:11], v[74:75], v[74:75], v[10:11]
    v_pk_fma_f32 v[8:9], v[76:77], v[76:77], v[8:9]
    v_pk_fma_f32 v[10:11], v[78:79], v[78:79], v[10:11]
    v_pk_fma_f32 v[8:9], v[80:81], v[80:81], v[8:9]
    v_pk_fma_f32 v[10:11], v[82:83], v[82:83], v[10:11]
    v_pk_fma_f32 v[8:9], v[84:85], v[84:85], v[8:9]
    v_pk_fma_f32 v[10:11], v[86:87], v[86:87], v[10:11]
    v_pk_fma_f32 v[8:9], v[88:89], v[88:89], v[8:9]
    v_pk_fma_f32 v[10:11], v[90:91], v[90:91], v[10:11]
    v_pk_fma_f32 v[8:9], v[92:93], v[92:93], v[8:9]
    v_pk_fma_f32 v[10:11], v[94:95], v[94:95], v[10:11]
    v_pk_fma_f32 v[8:9], v[96:97], v[96:97], v[8:9]
    v_pk_fma_f32 v[10:11], v[98:99], v[98:99], v[10:11]
    v_pk_fma_f32 v[8:9], v[100:101], v[100:101], v[8:9]
    v_pk_fma_f32 v[10:11], v[102:103], v[102:103], v[10:11]
    v_add_f32 v8, v8, v9
    v_add_f32 v10, v10, v11
    v_add_f32 v13, v8, v10
    s_nop 1
    v_add_f32_dpp v13, v13, v13 quad_perm:[1,0,3,2] row_mask:0xf bank_mask:0xf
    s_nop 1
    v_add_f32_dpp v13, v13, v13 quad_perm:[2,3,0,1] row_mask:0xf bank_mask:0xf
    s_nop 1
    v_add_f32_dpp v13, v13, v13 row_half_mirror row_mask:0xf bank_mask:0xf
    v_mul_f32 v13, 0x3b124925, v13
    v_cvt_pk_bf16_f32 v14, v12, v12
    v_lshlrev_b32 v14, 16, v14
    v_cvt_pk_bf16_f32 v13, v13, v13
    v_lshlrev_b32 v13, 16, v13
    v_add_f32 v13, 0x3727c5ac, v13
    v_cvt_pk_bf16_f32 v13, v13, v13
    v_lshlrev_b32 v13, 16, v13
    v_sqrt_f32 v13, v13
    s_nop 0
    v_cvt_pk_bf16_f32 v13, v13, v13
    v_lshlrev_b32 v13, 16, v13
    v_rcp_f32 v15, v13
    v_cmp_eq_u32 vcc, 0, v4
    s_nop 0
    s_and_saveexec_b64 s[14:15], vcc
    s_mov_b32 s11, 0xb00000
    buffer_store_dwordx2 v[14:15], v2, s[64:67], s11 offen offset:0 sc1
    s_mov_b64 exec, s[14:15]
    s_waitcnt vmcnt(1)
    v_lshlrev_b32 v48, 16, v140
    v_and_b32 v49, s12, v140
    v_lshlrev_b32 v50, 16, v141
    v_and_b32 v51, s12, v141
    v_lshlrev_b32 v52, 16, v142
    v_and_b32 v53, s12, v142
    v_lshlrev_b32 v54, 16, v143
    v_and_b32 v55, s12, v143
    v_lshlrev_b32 v56, 16, v144
    v_and_b32 v57, s12, v144
    v_lshlrev_b32 v58, 16, v145
    v_and_b32 v59, s12, v145
    v_lshlrev_b32 v60, 16, v146
    v_and_b32 v61, s12, v146
    v_lshlrev_b32 v62, 16, v147
    v_and_b32 v63, s12, v147
    v_lshlrev_b32 v64, 16, v148
    v_and_b32 v65, s12, v148
    v_lshlrev_b32 v66, 16, v149
    v_and_b32 v67, s12, v149
    v_lshlrev_b32 v68, 16, v150
    v_and_b32 v69, s12, v150
    v_lshlrev_b32 v70, 16, v151
    v_and_b32 v71, s12, v151
    v_lshlrev_b32 v72, 16, v152
    v_and_b32 v73, s12, v152
    v_lshlrev_b32 v74, 16, v153
    v_and_b32 v75, s12, v153
    v_lshlrev_b32 v76, 16, v154
    v_and_b32 v77, s12, v154
    v_lshlrev_b32 v78, 16, v155
    v_and_b32 v79, s12, v155
    v_lshlrev_b32 v80, 16, v156
    v_and_b32 v81, s12, v156
    v_lshlrev_b32 v82, 16, v157
    v_and_b32 v83, s12, v157
    v_lshlrev_b32 v84, 16, v158
    v_and_b32 v85, s12, v158
    v_lshlrev_b32 v86, 16, v159
    v_and_b32 v87, s12, v159
    v_lshlrev_b32 v88, 16, v160
    v_and_b32 v89, s12, v160
    v_lshlrev_b32 v90, 16, v161
    v_and_b32 v91, s12, v161
    v_lshlrev_b32 v92, 16, v162
    v_and_b32 v93, s12, v162
    v_lshlrev_b32 v94, 16, v163
    v_and_b32 v95, s12, v163
    v_lshlrev_b32 v96, 16, v164
    v_and_b32 v97, s12, v164
    v_lshlrev_b32 v98, 16, v165
    v_and_b32 v99, s12, v165
    v_lshlrev_b32 v100, 16, v166
    v_and_b32 v101, s12, v166
    v_lshlrev_b32 v102, 16, v167
    v_and_b32 v103, s12, v167
    v_pk_add_f32 v[8:9], v[48:49], v[52:53]
    v_pk_add_f32 v[10:11], v[50:51], v[54:55]
    v_pk_add_f32 v[8:9], v[8:9], v[56:57]
    v_pk_add_f32 v[10:11], v[10:11], v[58:59]
    v_pk_add_f32 v[8:9], v[8:9], v[60:61]
    v_pk_add_f32 v[10:11], v[10:11], v[62:63]
    v_pk_add_f32 v[8:9], v[8:9], v[64:65]
    v_pk_add_f32 v[10:11], v[10:11], v[66:67]
    v_pk_add_f32 v[8:9], v[8:9], v[68:69]
    v_pk_add_f32 v[10:11], v[10:11], v[70:71]
    v_pk_add_f32 v[8:9], v[8:9], v[72:73]
    v_pk_add_f32 v[10:11], v[10:11], v[74:75]
    v_pk_add_f32 v[8:9], v[8:9], v[76:77]
    v_pk_add_f32 v[10:11], v[10:11], v[78:79]
    v_pk_add_f32 v[8:9], v[8:9], v[80:81]
    v_pk_add_f32 v[10:11], v[10:11], v[82:83]
    v_pk_add_f32 v[8:9], v[8:9], v[84:85]
    v_pk_add_f32 v[10:11], v[10:11], v[86:87]
    v_pk_add_f32 v[8:9], v[8:9], v[88:89]
    v_pk_add_f32 v[10:11], v[10:11], v[90:91]
    v_pk_add_f32 v[8:9], v[8:9], v[92:93]
    v_pk_add_f32 v[10:11], v[10:11], v[94:95]
    v_pk_add_f32 v[8:9], v[8:9], v[96:97]
    v_pk_add_f32 v[10:11], v[10:11], v[98:99]
    v_pk_add_f32 v[8:9], v[8:9], v[100:101]
    v_pk_add_f32 v[10:11], v[10:11], v[102:103]
    v_add_f32 v8, v8, v9
    v_add_f32 v10, v10, v11
    v_add_f32 v12, v8, v10
    s_nop 1
    v_add_f32_dpp v12, v12, v12 quad_perm:[1,0,3,2] row_mask:0xf bank_mask:0xf
    s_nop 1
    v_add_f32_dpp v12, v12, v12 quad_perm:[2,3,0,1] row_mask:0xf bank_mask:0xf
    s_nop 1
    v_add_f32_dpp v12, v12, v12 row_half_mirror row_mask:0xf bank_mask:0xf
    v_mul_f32 v12, 0x3b124925, v12
    v_pk_add_f32 v[48:49], v[48:49], v[12:13] op_sel_hi:[1,0] neg_lo:[0,1] neg_hi:[0,1]
    v_pk_add_f32 v[50:51], v[50:51], v[12:13] op_sel_hi:[1,0] neg_lo:[0,1] neg_hi:[0,1]
    v_pk_add_f32 v[52:53], v[52:53], v[12:13] op_sel_hi:[1,0] neg_lo:[0,1] neg_hi:[0,1]
    v_pk_add_f32 v[54:55], v[54:55], v[12:13] op_sel_hi:[1,0] neg_lo:[0,1] neg_hi:[0,1]
    v_pk_add_f32 v[56:57], v[56:57], v[12:13] op_sel_hi:[1,0] neg_lo:[0,1] neg_hi:[0,1]
    v_pk_add_f32 v[58:59], v[58:59], v[12:13] op_sel_hi:[1,0] neg_lo:[0,1] neg_hi:[0,1]
    v_pk_add_f32 v[60:61], v[60:61], v[12:13] op_sel_hi:[1,0] neg_lo:[0,1] neg_hi:[0,1]
    v_pk_add_f32 v[62:63], v[62:63], v[12:13] op_sel_hi:[1,0] neg_lo:[0,1] neg_hi:[0,1]
    v_pk_add_f32 v[64:65], v[64:65], v[12:13] op_sel_hi:[1,0] neg_lo:[0,1] neg_hi:[0,1]
    v_pk_add_f32 v[66:67], v[66:67], v[12:13] op_sel_hi:[1,0] neg_lo:[0,1] neg_hi:[0,1]
    v_pk_add_f32 v[68:69], v[68:69], v[12:13] op_sel_hi:[1,0] neg_lo:[0,1] neg_hi:[0,1]
    v_pk_add_f32 v[70:71], v[70:71], v[12:13] op_sel_hi:[1,0] neg_lo:[0,1] neg_hi:[0,1]
    v_pk_add_f32 v[72:73], v[72:73], v[12:13] op_sel_hi:[1,0] neg_lo:[0,1] neg_hi:[0,1]
    v_pk_add_f32 v[74:75], v[74:75], v[12:13] op_sel_hi:[1,0] neg_lo:[0,1] neg_hi:[0,1]
    v_pk_add_f32 v[76:77], v[76:77], v[12:13] op_sel_hi:[1,0] neg_lo:[0,1] neg_hi:[0,1]
    v_pk_add_f32 v[78:79], v[78:79], v[12:13] op_sel_hi:[1,0] neg_lo:[0,1] neg_hi:[0,1]
    v_pk_add_f32 v[80:81], v[80:81], v[12:13] op_sel_hi:[1,0] neg_lo:[0,1] neg_hi:[0,1]
    v_pk_add_f32 v[82:83], v[82:83], v[12:13] op_sel_hi:[1,0] neg_lo:[0,1] neg_hi:[0,1]
    v_pk_add_f32 v[84:85], v[84:85], v[12:13] op_sel_hi:[1,0] neg_lo:[0,1] neg_hi:[0,1]
    v_pk_add_f32 v[86:87], v[86:87], v[12:13] op_sel_hi:[1,0] neg_lo:[0,1] neg_hi:[0,1]
    v_pk_add_f32 v[88:89], v[88:89], v[12:13] op_sel_hi:[1,0] neg_lo:[0,1] neg_hi:[0,1]
    v_pk_add_f32 v[90:91], v[90:91], v[12:13] op_sel_hi:[1,0] neg_lo:[0,1] neg_hi:[0,1]
    v_pk_add_f32 v[92:93], v[92:93], v[12:13] op_sel_hi:[1,0] neg_lo:[0,1] neg_hi:[0,1]
    v_pk_add_f32 v[94:95], v[94:95], v[12:13] op_sel_hi:[1,0] neg_lo:[0,1] neg_hi:[0,1]
    v_pk_add_f32 v[96:97], v[96:97], v[12:13] op_sel_hi:[1,0] neg_lo:[0,1] neg_hi:[0,1]
    v_pk_add_f32 v[98:99], v[98:99], v[12:13] op_sel_hi:[1,0] neg_lo:[0,1] neg_hi:[0,1]
    v_pk_add_f32 v[100:101], v[100:101], v[12:13] op_sel_hi:[1,0] neg_lo:[0,1] neg_hi:[0,1]
    v_pk_add_f32 v[102:103], v[102:103], v[12:13] op_sel_hi:[1,0] neg_lo:[0,1] neg_hi:[0,1]
    v_pk_mul_f32 v[8:9], v[48:49], v[48:49]
    v_pk_mul_f32 v[10:11], v[50:51], v[50:51]
    v_pk_fma_f32 v[8:9], v[52:53], v[52:53], v[8:9]
    v_pk_fma_f32 v[10:11], v[54:55], v[54:55], v[10:11]
    v_pk_fma_f32 v[8:9], v[56:57], v[56:57], v[8:9]
    v_pk_fma_f32 v[10:11], v[58:59], v[58:59], v[10:11]
    v_pk_fma_f32 v[8:9], v[60:61], v[60:61], v[8:9]
    v_pk_fma_f32 v[10:11], v[62:63], v[62:63], v[10:11]
    v_pk_fma_f32 v[8:9], v[64:65], v[64:65], v[8:9]
    v_pk_fma_f32 v[10:11], v[66:67], v[66:67], v[10:11]
    v_pk_fma_f32 v[8:9], v[68:69], v[68:69], v[8:9]
    v_pk_fma_f32 v[10:11], v[70:71], v[70:71], v[10:11]
    v_pk_fma_f32 v[8:9], v[72:73], v[72:73], v[8:9]
    v_pk_fma_f32 v[10:11], v[74:75], v[74:75], v[10:11]
    v_pk_fma_f32 v[8:9], v[76:77], v[76:77], v[8:9]
    v_pk_fma_f32 v[10:11], v[78:79], v[78:79], v[10:11]
    v_pk_fma_f32 v[8:9], v[80:81], v[80:81], v[8:9]
    v_pk_fma_f32 v[10:11], v[82:83], v[82:83], v[10:11]
    v_pk_fma_f32 v[8:9], v[84:85], v[84:85], v[8:9]
    v_pk_fma_f32 v[10:11], v[86:87], v[86:87], v[10:11]
    v_pk_fma_f32 v[8:9], v[88:89], v[88:89], v[8:9]
    v_pk_fma_f32 v[10:11], v[90:91], v[90:91], v[10:11]
    v_pk_fma_f32 v[8:9], v[92:93], v[92:93], v[8:9]
    v_pk_fma_f32 v[10:11], v[94:95], v[94:95], v[10:11]
    v_pk_fma_f32 v[8:9], v[96:97], v[96:97], v[8:9]
    v_pk_fma_f32 v[10:11], v[98:99], v[98:99], v[10:11]
    v_pk_fma_f32 v[8:9], v[100:101], v[100:101], v[8:9]
    v_pk_fma_f32 v[10:11], v[102:103], v[102:103], v[10:11]
    v_add_f32 v8, v8, v9
    v_add_f32 v10, v10, v11
    v_add_f32 v13, v8, v10
    s_nop 1
    v_add_f32_dpp v13, v13, v13 quad_perm:[1,0,3,2] row_mask:0xf bank_mask:0xf
    s_nop 1
    v_add_f32_dpp v13, v13, v13 quad_perm:[2,3,0,1] row_mask:0xf bank_mask:0xf
    s_nop 1
    v_add_f32_dpp v13, v13, v13 row_half_mirror row_mask:0xf bank_mask:0xf
    v_mul_f32 v13, 0x3b124925, v13
    v_cvt_pk_bf16_f32 v16, v12, v12
    v_lshlrev_b32 v16, 16, v16
    v_cvt_pk_bf16_f32 v13, v13, v13
    v_lshlrev_b32 v13, 16, v13
    v_add_f32 v13, 0x3727c5ac, v13
    v_cvt_pk_bf16_f32 v13, v13, v13
    v_lshlrev_b32 v13, 16, v13
    v_sqrt_f32 v13, v13
    s_nop 0
    v_cvt_pk_bf16_f32 v13, v13, v13
    v_lshlrev_b32 v13, 16, v13
    v_rcp_f32 v17, v13
    v_cmp_eq_u32 vcc, 0, v4
    s_nop 0
    s_and_saveexec_b64 s[14:15], vcc
    s_mov_b32 s11, 0xb00000
    buffer_store_dwordx2 v[16:17], v2, s[64:67], s11 offen offset:64 sc1
    s_mov_b64 exec, s[14:15]
    s_waitcnt vmcnt(0)
    v_mov_b32 v202, 1
    s_mov_b64 exec, 1
    ds_add_rtn_u32 v203, v200, v202
    s_waitcnt lgkmcnt(0)
    v_readfirstlane_b32 s11, v203
    s_nop 0
    s_cmp_lg_u32 s11, 7
    s_cbranch_scc1 L_h_nsa
    global_atomic_add v201, v202, s[44:45] sc1
L_h_nsa:
    s_mov_b64 exec, -1
    s_endpgm
L_h_pf:
    v_lshlrev_b32 v2, 4, v0
    s_lshl_b32 s11, s10, 10
    v_add_u32 v2, s11, v2
    s_waitcnt lgkmcnt(0)
    s_mov_b32 s64, s46
    s_and_b32 s65, s47, 0xffff
    s_mov_b32 s66, 0x1000000
    s_mov_b32 s67, 0x20000
    s_lshl_b32 s60, s72, 2
    s_add_u32 s60, s60, s10
    s_cmp_ge_u32 s60, 98
    s_cbranch_scc1 L_h_nopack1
    s_mul_i32 s61, s60, 37
    s_lshr_b32 s61, s61, 8
    s_mul_i32 s62, s61, 7
    s_sub_u32 s62, s60, s62
    s_cmp_lt_i32 s62, 0
    s_cselect_b32 s11, 1, 0
    s_sub_u32 s61, s61, s11
    s_mul_i32 s62, s61, 7
    s_sub_u32 s62, s60, s62
    s_bitcmp1_b32 s61, 0
    s_cselect_b32 s68, s28, s26
    s_cselect_b32 s69, s29, s27
    s_and_b32 s69, s69, 0xffff
    s_mov_b32 s70, 0x62000
    s_mov_b32 s71, 0x20000
    v_lshrrev_b32 v3, 3, v0
    v_and_b32 v4, 7, v0
    v_lshrrev_b32 v5, 1, v3
    v_xor_b32 v4, v4, v5
    s_lshr_b32 s11, s61, 1
    s_lshl_b32 s11, s11, 6
    v_add_u32 v3, s11, v3
    v_mul_u32_u24 v3, 896, v3
    v_lshl_add_u32 v3, v4, 4, v3
    v_xor_b32 v4, 64, v3
    s_lshl_b32 s63, s10, 13
    s_lshl_b32 s12, s62, 7
    s_add_u32 m0, s63, 0
    s_add_u32 s11, s12, 0
    buffer_load_dwordx4 v3, s[68:71], s11 offen lds
    s_add_u32 m0, s63, 1024
    s_add_u32 s11, s12, 7168
    buffer_load_dwordx4 v4, s[68:71], s11 offen lds
    s_add_u32 m0, s63, 2048
    s_add_u32 s11, s12, 14336
    buffer_load_dwordx4 v3, s[68:71], s11 offen lds
    s_add_u32 m0, s63, 3072
    s_add_u32 s11, s12, 21504
    buffer_load_dwordx4 v4, s[68:71], s11 offen lds
    s_add_u32 m0, s63, 4096
    s_add_u32 s11, s12, 28672
    buffer_load_dwordx4 v3, s[68:71], s11 offen lds
    s_add_u32 m0, s63, 5120
    s_add_u32 s11, s12, 35840
    buffer_load_dwordx4 v4, s[68:71], s11 offen lds
    s_add_u32 m0, s63, 6144
    s_add_u32 s11, s12, 43008
    buffer_load_dwordx4 v3, s[68:71], s11 offen lds
    s_add_u32 m0, s63, 7168
    s_add_u32 s11, s12, 50176
    buffer_load_dwordx4 v4, s[68:71], s11 offen lds
L_h_nopack1:
    s_waitcnt lgkmcnt(0)
    s_barrier
    s_cmp_ge_u32 s60, 98
    s_cbranch_scc1 L_h_nopack2
    v_and_b32 v5, 31, v0
    v_lshrrev_b32 v6, 5, v0
    v_bfe_u32 v7, v0, 1, 3
    v_xor_b32 v7, v7, v6
    v_lshlrev_b32 v7, 4, v7
    v_lshl_add_u32 v5, v5, 7, v7
    v_add_u32 v5, s63, v5
    v_lshlrev_b32 v6, 4, v0
    s_mul_i32 s12, s61, 28
    s_lshl_b32 s11, s62, 2
    s_add_u32 s12, s12, s11
    s_lshl_b32 s12, s12, 11
    s_add_u32 s12, s12, 0xb20000
    s_waitcnt vmcnt(0)
    v_xor_b32 v7, 0, v5
    ds_read_b128 v[32:35], v7 offset:0
    ds_read_b128 v[36:39], v7 offset:4096
    v_xor_b32 v7, 32, v5
    ds_read_b128 v[40:43], v7 offset:0
    ds_read_b128 v[44:47], v7 offset:4096
    v_xor_b32 v7, 64, v5
    ds_read_b128 v[48:51], v7 offset:0
    ds_read_b128 v[52:55], v7 offset:4096
    v_xor_b32 v7, 96, v5
    ds_read_b128 v[56:59], v7 offset:0
    ds_read_b128 v[60:63], v7 offset:4096
    s_waitcnt lgkmcnt(6)
    s_add_u32 s11, s12, 0
    buffer_store_dwordx4 v[32:35], v6, s[64:67], s11 offen offset:0 sc1
    buffer_store_dwordx4 v[36:39], v6, s[64:67], s11 offen offset:1024 sc1
    s_waitcnt lgkmcnt(4)
    s_add_u32 s11, s12, 2048
    buffer_store_dwordx4 v[40:43], v6, s[64:67], s11 offen offset:0 sc1
    buffer_store_dwordx4 v[44:47], v6, s[64:67], s11 offen offset:1024 sc1
    s_waitcnt lgkmcnt(2)
    s_add_u32 s11, s12, 4096
    buffer_store_dwordx4 v[48:51], v6, s[64:67], s11 offen offset:0 sc1
    buffer_store_dwordx4 v[52:55], v6, s[64:67], s11 offen offset:1024 sc1
    s_waitcnt lgkmcnt(0)
    s_add_u32 s11, s12, 6144
    buffer_store_dwordx4 v[56:59], v6, s[64:67], s11 offen offset:0 sc1
    buffer_store_dwordx4 v[60:63], v6, s[64:67], s11 offen offset:1024 sc1
    s_waitcnt vmcnt(0)
L_h_nopack2:
    v_mov_b32 v202, 1
    s_mov_b64 exec, 1
    ds_add_rtn_u32 v203, v200, v202
    s_waitcnt lgkmcnt(0)
    v_readfirstlane_b32 s11, v203
    s_nop 0
    s_cmp_lg_u32 s11, 7
    s_cbranch_scc1 L_h_nsb
    global_atomic_add v201, v202, s[44:45] sc1
L_h_nsb:
    s_mov_b64 exec, -1
    s_mov_b32 s56, s40
    s_and_b32 s57, s41, 0xffff
    s_mov_b32 s58, 0x188000
    s_mov_b32 s59, 0x20000
    s_mul_i32 s12, s73, 401408
    s_add_u32 s13, s4, 0
    s_and_b32 s13, s13, 7
    s_mul_i32 s13, s13, 13
    s_mov_b32 s14, 0
L_h_p2:
    s_lshl_b32 s11, s13, 12
    s_add_u32 s11, s11, s12
    buffer_load_dwordx4 v[16:19], v2, s[56:59], s11 offen
    s_add_u32 s13, s13, 1
    s_cmp_eq_u32 s13, 104
    s_cselect_b32 s13, 0, s13
    s_add_u32 s14, s14, 1
    s_cmp_lt_u32 s14, 13
    s_cbranch_scc1 L_h_p2
    s_endpgm
L_exit:
    s_endpgm
.section .rodata,"a"
.p2align 6
.amdhsa_kernel recurrent_scan__ssm_conv_s5__glu_gated_reglu__prompt_kernel
  .amdhsa_next_free_vgpr 256
  .amdhsa_next_free_sgpr 102
  .amdhsa_accum_offset 256
  .amdhsa_group_segment_fixed_size 0
  .amdhsa_kernarg_size 128
  .amdhsa_user_sgpr_count 2
  .amdhsa_user_sgpr_kernarg_segment_ptr 1
  .amdhsa_system_sgpr_workgroup_id_x 1
  .amdhsa_float_denorm_mode_32 3
.end_amdhsa_kernel
```
